```python
import torch

def _softmax(x, axis=-1):
    return torch.softmax(x, dim=axis)
def _gelu(x):
    return torch.nn.functional.gelu(x, approximate="tanh")
def _silu(x):
    return torch.nn.functional.silu(x)
def _sigmoid(x):
    return torch.sigmoid(x)
def _layernorm(x, axis=-1, eps=1e-5):
    m = x.mean(dim=axis, keepdim=True)
    v = x.var(dim=axis, keepdim=True, unbiased=False)
    return (x - m) / torch.sqrt(v + eps)
def _scatter_add(tgt, idx, src, axis=0):
    return tgt.clone().index_add_(axis, idx, src)
def _segment_sum(src, seg, n):
    out = torch.zeros((n,) + src.shape[1:], dtype=src.dtype)
    return out.index_add_(0, seg, src)
def _pad(x, pw):
    flat = tuple(v for pair in reversed(pw) for v in pair)
    return torch.nn.functional.pad(x, flat)

kernel_name = 'concat_heads__mha_block_cached__sliding_block_cached__decode'

def setup_inputs():

    _w = (lambda a: (lambda t: t.to(torch.bfloat16) if t.is_floating_point() else t)(torch.as_tensor(a)))
    def _A_setup():
        B, Sq, D = 4, 1, 448
        H, Sk, Dh = 16, 4096, 256
        return {
            "x": _w((lambda *s: torch.randn(*s, dtype=torch.bfloat16) * 0.8)(B, Sq, D)),
            "k_cache": _w((lambda *s: torch.randn(*s, dtype=torch.bfloat16) * 1.6)(B, H, Sk, Dh)),
            "v_cache": _w((lambda *s: torch.randn(*s, dtype=torch.bfloat16) * 0.2)(B, H, Sk, Dh)),
            "wq": _w((lambda *s: torch.randn(*s, dtype=torch.bfloat16) * 1.6)(D, H * Dh) * (D ** -0.5)),
            "wo": _w((lambda *s: torch.randn(*s, dtype=torch.bfloat16) * 0.2)(H * Dh, D) * ((H * Dh) ** -0.5)),
        }
    _A_in = _A_setup()

    def _B_setup():
        B, Sq, D = 4, 1, 448
        Hq, Hkv, Sk, Dh = 16, 8, 4096, 256
        assert Hq % Hkv == 0, (Hq, Hkv)
        return {
            "x": _w((lambda *s: torch.randn(*s, dtype=torch.bfloat16) * 0.8)(B, Sq, D)),
            "k_cache": _w((lambda *s: torch.randn(*s, dtype=torch.bfloat16) * 1.6)(B, Hkv, Sk, Dh)),
            "v_cache": _w((lambda *s: torch.randn(*s, dtype=torch.bfloat16) * 0.2)(B, Hkv, Sk, Dh)),
            "wq": _w((lambda *s: torch.randn(*s, dtype=torch.bfloat16) * 1.6)(D, Hq * Dh) * (D ** -0.5)),
            "wo": _w((lambda *s: torch.randn(*s, dtype=torch.bfloat16) * 0.2)(Hq * Dh, D) * ((Hq * Dh) ** -0.5)),
        }
    _B_in = _B_setup()

    return {
        "A_x": _A_in["x"],
        "A_k_cache": _A_in["k_cache"],
        "A_v_cache": _A_in["v_cache"],
        "A_wq": _A_in["wq"],
        "A_wo": _A_in["wo"],
        "B_x": _B_in["x"],
        "B_k_cache": _B_in["k_cache"],
        "B_v_cache": _B_in["v_cache"],
        "B_wq": _B_in["wq"],
        "B_wo": _B_in["wo"],
    }

def reference(A_x, A_k_cache, A_v_cache, A_wq, A_wo, B_x, B_k_cache, B_v_cache, B_wq, B_wo):
    def _A_ref(x, k_cache, v_cache, wq, wo):
        B, Sq, D = x.shape
        H, Dh = 16, 256
        q = (lambda x, *d: x.permute(*d))((x @ wq).reshape(B, Sq, H, Dh), 0, 2, 1, 3)
        scores = torch.einsum("bhqd,bhkd->bhqk", q, k_cache) * (Dh ** -0.5)
        p = _softmax(scores, axis=-1)
        o = torch.einsum("bhqk,bhkd->bhqd", p, v_cache)
        return (lambda x, *d: x.permute(*d))(o, 0, 2, 1, 3).reshape(B, Sq, H * Dh) @ wo

    def _B_ref(x, k_cache, v_cache, wq, wo):
        B, Sq, D = x.shape
        Hq, Dh = 16, 256
        Hkv, Sk = k_cache.shape[1], k_cache.shape[2]
        W = min(4096, max(256, Sk // 4))
        rep = Hq // Hkv
        q = (lambda x, *d: x.permute(*d))((x @ wq).reshape(B, Sq, Hq, Dh), 0, 2, 1, 3)
        k = (lambda x, n, axis: torch.repeat_interleave(x, n, dim=axis))(k_cache[:, :, Sk - W:, :], rep, axis=1)
        v = (lambda x, n, axis: torch.repeat_interleave(x, n, dim=axis))(v_cache[:, :, Sk - W:, :], rep, axis=1)
        scores = torch.einsum("bhqd,bhkd->bhqk", q, k) * (Dh ** -0.5)
        p = _softmax(scores, axis=-1)
        o = torch.einsum("bhqk,bhkd->bhqd", p, v)
        return (lambda x, *d: x.permute(*d))(o, 0, 2, 1, 3).reshape(B, Sq, Hq * Dh) @ wo

    a = _A_ref(A_x, A_k_cache, A_v_cache, A_wq, A_wo)
    b = _B_ref(B_x, B_k_cache, B_v_cache, B_wq, B_wo)
    return torch.concatenate([a, b], axis=-1)
```

```asm
; @launch grid=(256,1,1) block=(256,1,1) lds=10496
.amdgcn_target "amdgcn-amd-amdhsa--gfx950"
.text
.globl concat_heads__mha_block_cached__sliding_block_cached__decode_kernel
.p2align 8
.type concat_heads__mha_block_cached__sliding_block_cached__decode_kernel,@function
concat_heads__mha_block_cached__sliding_block_cached__decode_kernel:
    s_cmpk_ge_u32 s2, 256
    s_cbranch_scc1 L_end
    s_load_dwordx2 s[12:13], s[0:1], 48
    s_load_dwordx2 s[32:33], s[0:1], 96
    s_getpc_b64 s[38:39]
L_pc:
    s_lshr_b32 s3, s2, 3
    s_mul_i32 s3, s3, ((L_code_end-L_pc-772)/124)*4
    v_min_u32 v3, 6, v0
    v_lshl_add_u32 v3, v3, 7, s3
    global_load_dword v12, v3, s[38:39]
    s_and_b32 s50, s2, 7
    s_lshr_b32 s41, s2, 6
    s_lshl3_add_u32 s41, s41, s50
    s_bfe_u32 s40, s2, 0x30003
    s_lshl4_add_u32 s44, s41, 12
    s_lshl3_add_u32 s44, s44, s40
    s_lshl_b32 s44, s44, 14
    s_lshl_b32 s14, 1, 26
    s_mov_b32 s15, 0x20000
    v_lshrrev_b32 v2, 6, v0
    v_lshrrev_b32 v4, 2, v0
    v_and_b32 v3, 3, v0
    v_and_b32 v6, 3, v4
    v_lshl_add_u32 v8, v2, 2, v6
    v_lshl_add_u32 v8, v8, 6, v3
    v_and_b32 v7, 12, v4
    v_add_lshl_u32 v8, v8, v7, 4
    s_waitcnt lgkmcnt(0)
    buffer_load_dwordx4 a[0:3], v8, s[12:15], s44 offen nt
    buffer_load_dwordx4 a[4:7], v8, s[12:15], s44 offen offset:512 nt
    buffer_load_dwordx4 a[8:11], v8, s[12:15], s44 offen offset:256 nt
    s_lshr_b32 s55, s2, 7
    s_mul_i32 s55, s55, 40
    s_load_dwordx2 s[4:5], s[0:1], s55
    s_load_dwordx2 s[8:9], s[0:1], s55 offset:24
    s_load_dwordx2 s[56:57], s[0:1], 88
    s_getreg_b32 s51, hwreg(HW_REG_XCC_ID, 0, 4)
    s_mul_i32 s3, s2, 0x101
    s_bfe_u32 s3, s3, 0x80003
    v_mov_b32 v10, s3
    v_add_u32 v11, s51, 1
    s_bfe_u32 s3, s2, 0x40003
    s_lshl4_add_u32 s50, s50, s3
    s_lshl_b32 s45, s50, 6
    s_lshl3_add_u32 s2, s41, s40
    v_readfirstlane_b32 s42, v2
    v_lshlrev_b32 v7, 12, v4
    v_add_lshl_u32 v7, v7, v3, 4
    v_cmp_gt_u32 vcc, 56, v4
    v_mad_u32_u24 v6, v6, 55, v4
    v_add_lshl_u32 v6, v6, v3, 4
    v_cndmask_b32 v6, 2.0, v6, vcc
    s_mov_b32 s6, 3584
    s_mov_b32 s7, 0x20000
    s_mov_b32 s10, 3670016
    s_mov_b32 s11, 0x20000
    s_waitcnt lgkmcnt(0)
    global_store_byte v10, v11, s[56:57]
    buffer_load_dwordx4 v[16:19], v6, s[4:7], 0 offen
    buffer_load_dwordx4 v[20:23], v7, s[8:11], s45 offen
    s_addk_i32 s45, 0x2000
    buffer_load_dwordx4 v[24:27], v7, s[8:11], s45 offen
    s_addk_i32 s45, 0x2000
    buffer_load_dwordx4 v[28:31], v7, s[8:11], s45 offen
    s_addk_i32 s45, 0x2000
    buffer_load_dwordx4 v[32:35], v7, s[8:11], s45 offen
    buffer_load_dwordx4 a[12:15], v8, s[12:15], s44 offen offset:768 nt
    s_addk_i32 s45, 0x2000
    buffer_load_dwordx4 v[36:39], v7, s[8:11], s45 offen
    s_addk_i32 s45, 0x2000
    buffer_load_dwordx4 v[40:43], v7, s[8:11], s45 offen
    s_addk_i32 s45, 0x2000
    buffer_load_dwordx4 v[44:47], v7, s[8:11], s45 offen
    s_addk_i32 s45, 0x2000
    buffer_load_dwordx4 v[48:51], v7, s[8:11], s45 offen
    s_add_u32 s44, s44, 131072
    buffer_load_dwordx4 a[16:19], v8, s[12:15], s44 offen nt
    s_mul_i32 s3, s2, 3072
    s_add_u32 s3, s3, 262144
    v_mov_b32 v14, s3
    s_lshr_b32 s3, s2, 7
    s_lshl_b32 s3, s3, 9
    s_add_u32 s3, s3, s50
    s_lshl_b32 s3, s3, 7
    s_add_u32 s3, s3, 4294639616
    v_mul_u32_u24 v15, 16256, v0
    v_add_u32 v15, s3, v15
    v_cmp_gt_u32 vcc, 24, v0
    s_nop 1
    v_cndmask_b32 v14, v15, v14, vcc
    v_cmp_gt_u32 vcc, 28, v0
    s_nop 1
    v_cndmask_b32 v14, 2.0, v14, vcc
    v_lshlrev_b32 v15, 8, v10
    v_add_u32 v15, 1241344, v15
    v_cmp_gt_u32 vcc, 30, v0
    s_nop 1
    v_cndmask_b32 v14, v15, v14, vcc
    v_lshl_add_u32 v14, v0, 7, v14
    v_cmp_gt_u32 vcc, 32, v0
    s_nop 1
    v_cndmask_b32 v14, 2.0, v14, vcc
    s_mov_b32 s34, 16777216
    s_mov_b32 s35, 0x20000
    buffer_load_dword v15, v14, s[32:35], 0 offen sc1
    s_bfe_u32 s55, s2, 0x10005
    s_mul_i32 s55, s55, 40
    s_load_dword s43, s[32:33], 0
    s_load_dwordx2 s[16:17], s[0:1], 56
    s_load_dwordx2 s[20:21], s[0:1], 8
    s_load_dwordx2 s[24:25], s[0:1], 16
    s_load_dwordx2 s[28:29], s[0:1], s55 offset:32
    s_load_dwordx2 s[36:37], s[0:1], 80
    v_and_b32 v1, 63, v0
    v_mov_b32 v5, 2146435072
    s_mov_b32 s18, 67108864
    s_mov_b32 s19, 0x20000
    s_mov_b32 s22, 134217728
    s_mov_b32 s23, 0x20000
    s_mov_b32 s26, 134217728
    s_mov_b32 s27, 0x20000
    s_mov_b32 s30, 3670016
    s_mov_b32 s31, 0x20000
    s_mov_b32 s38, 7168
    s_mov_b32 s39, 0x20000
    s_mov_b32 s46, 0x05040100
    s_mov_b32 s47, 0x07060302
    s_mov_b32 s48, 0x3db8aa3b
    s_mov_b32 s49, 0
    v_mul_u32_u24 v56, 12, v1
    v_lshlrev_b32 v59, 2, v1
    v_lshlrev_b32 v57, 3, v0
    v_and_b32 v58, 3, v0
    v_bfe_u32 v2, v0, 3, 2
    v_lshl_add_u32 v58, v58, 2, v2
    v_lshrrev_b32 v2, 6, v0
    v_lshl_add_u32 v58, v2, 4, v58
    v_bfe_u32 v2, v0, 2, 1
    v_lshl_add_u32 v58, v58, 1, v2
    v_bfe_u32 v2, v0, 5, 1
    v_lshl_add_u32 v58, v2, 8, v58
    v_lshlrev_b32 v58, 2, v58
    v_lshrrev_b32 v2, 3, v0
    v_and_b32 v3, 7, v0
    v_lshlrev_b32 v9, 9, v2
    v_lshl_add_u32 v9, v3, 4, v9
    buffer_load_dwordx4 a[20:23], v8, s[12:15], s44 offen offset:512 nt
    v_and_b32 v10, 0xe0, v10
    v_and_or_b32 v10, v0, 31, v10
    global_load_ubyte v102, v10, s[56:57]
    s_waitcnt vmcnt(17)
    buffer_load_dwordx4 a[24:27], v8, s[12:15], s44 offen offset:256 nt
    s_waitcnt vmcnt(17)
    buffer_load_dwordx4 a[28:31], v8, s[12:15], s44 offen offset:768 nt
    s_add_u32 s44, s44, 131072
    s_waitcnt vmcnt(17)
    buffer_load_dwordx4 a[32:35], v8, s[12:15], s44 offen nt
    s_waitcnt vmcnt(7)
    v_perm_b32 v92, v24, v20, s46
    v_perm_b32 v93, v32, v28, s46
    v_perm_b32 v94, v40, v36, s46
    v_perm_b32 v95, v48, v44, s46
    s_nop 1
    v_mfma_f32_16x16x32_bf16 v[60:63], v[16:19], v[92:95], 0
    v_perm_b32 v96, v24, v20, s47
    v_perm_b32 v97, v32, v28, s47
    v_perm_b32 v98, v40, v36, s47
    v_perm_b32 v99, v48, v44, s47
    s_nop 1
    v_mfma_f32_16x16x32_bf16 v[64:67], v[16:19], v[96:99], 0
    v_perm_b32 v92, v25, v21, s46
    v_perm_b32 v93, v33, v29, s46
    v_perm_b32 v94, v41, v37, s46
    v_perm_b32 v95, v49, v45, s46
    s_nop 1
    v_mfma_f32_16x16x32_bf16 v[68:71], v[16:19], v[92:95], 0
    v_perm_b32 v96, v25, v21, s47
    v_perm_b32 v97, v33, v29, s47
    v_perm_b32 v98, v41, v37, s47
    v_perm_b32 v99, v49, v45, s47
    s_nop 1
    v_mfma_f32_16x16x32_bf16 v[72:75], v[16:19], v[96:99], 0
    buffer_load_dwordx4 a[36:39], v8, s[12:15], s44 offen offset:512 nt
    v_perm_b32 v92, v26, v22, s46
    v_perm_b32 v93, v34, v30, s46
    v_perm_b32 v94, v42, v38, s46
    v_perm_b32 v95, v50, v46, s46
    s_nop 1
    v_mfma_f32_16x16x32_bf16 v[76:79], v[16:19], v[92:95], 0
    v_perm_b32 v96, v26, v22, s47
    v_perm_b32 v97, v34, v30, s47
    v_perm_b32 v98, v42, v38, s47
    v_perm_b32 v99, v50, v46, s47
    s_nop 1
    v_mfma_f32_16x16x32_bf16 v[80:83], v[16:19], v[96:99], 0
    v_perm_b32 v92, v27, v23, s46
    v_perm_b32 v93, v35, v31, s46
    v_perm_b32 v94, v43, v39, s46
    v_perm_b32 v95, v51, v47, s46
    s_nop 1
    v_mfma_f32_16x16x32_bf16 v[84:87], v[16:19], v[92:95], 0
    v_perm_b32 v96, v27, v23, s47
    v_perm_b32 v97, v35, v31, s47
    v_perm_b32 v98, v43, v39, s47
    v_perm_b32 v99, v51, v47, s47
    s_nop 1
    v_mfma_f32_16x16x32_bf16 v[88:91], v[16:19], v[96:99], 0
    v_add_f32_dpp v24, v61, v60 row_ror:12 row_mask:0xf bank_mask:0xf
    s_waitcnt vmcnt(7)
    buffer_load_dwordx4 a[40:43], v8, s[12:15], s44 offen offset:256 nt
    v_add_f32_dpp v25, v64, v65 row_ror:4 row_mask:0xf bank_mask:0xf
    v_add_f32_dpp v26, v68, v70 row_ror:8 row_mask:0xf bank_mask:0xf
    v_add_f32_dpp v27, v72, v75 row_ror:12 row_mask:0xf bank_mask:0xf
    v_add_f32_dpp v24, v62, v24 row_ror:8 row_mask:0xf bank_mask:0xf
    v_add_f32_dpp v25, v66, v25 row_ror:12 row_mask:0xf bank_mask:0xf
    v_add_f32_dpp v26, v69, v26 row_ror:4 row_mask:0xf bank_mask:0xf
    v_add_f32_dpp v27, v73, v27 row_ror:8 row_mask:0xf bank_mask:0xf
    v_add_f32_dpp v20, v63, v24 row_ror:4 row_mask:0xf bank_mask:0x1
    v_add_f32_dpp v20, v67, v25 row_ror:8 row_mask:0xf bank_mask:0x2
    v_add_f32_dpp v20, v71, v26 row_ror:12 row_mask:0xf bank_mask:0x4
    v_add_f32_dpp v20, v74, v27 row_ror:4 row_mask:0xf bank_mask:0x8
    v_add_f32_dpp v24, v77, v76 row_ror:12 row_mask:0xf bank_mask:0xf
    v_add_f32_dpp v25, v80, v81 row_ror:4 row_mask:0xf bank_mask:0xf
    v_add_f32_dpp v26, v84, v86 row_ror:8 row_mask:0xf bank_mask:0xf
    v_add_f32_dpp v27, v88, v91 row_ror:12 row_mask:0xf bank_mask:0xf
    v_add_f32_dpp v24, v78, v24 row_ror:8 row_mask:0xf bank_mask:0xf
    v_add_f32_dpp v25, v82, v25 row_ror:12 row_mask:0xf bank_mask:0xf
    s_waitcnt vmcnt(6)
    buffer_load_dwordx4 a[44:47], v8, s[12:15], s44 offen offset:768 nt
    v_add_f32_dpp v26, v85, v26 row_ror:4 row_mask:0xf bank_mask:0xf
    v_add_f32_dpp v27, v89, v27 row_ror:8 row_mask:0xf bank_mask:0xf
    v_add_f32_dpp v21, v79, v24 row_ror:4 row_mask:0xf bank_mask:0x1
    v_add_f32_dpp v21, v83, v25 row_ror:8 row_mask:0xf bank_mask:0x2
    v_add_f32_dpp v21, v87, v26 row_ror:12 row_mask:0xf bank_mask:0x4
    v_add_f32_dpp v21, v90, v27 row_ror:4 row_mask:0xf bank_mask:0x8
    ds_write_b64 v57, v[20:21] offset:0
    s_waitcnt lgkmcnt(0)
    s_add_u32 s44, s44, 131072
    s_waitcnt vmcnt(5)
    buffer_load_dwordx4 a[48:51], v8, s[12:15], s44 offen nt
    s_barrier
    ds_read2st64_b32 v[20:21], v58 offset0:0 offset1:2
    s_add_u32 s43, s43, 0x9e3779b9
    s_lshr_b32 s3, s2, 7
    s_lshl2_add_u32 s3, s3, s42
    s_lshl_b32 s3, s3, 7
    s_add_u32 s3, s3, s50
    s_lshl_b32 s3, s3, 7
    s_add_u32 s3, s3, 65536
    v_mov_b32 v29, s43
    s_waitcnt lgkmcnt(0)
    s_waitcnt vmcnt(5)
    buffer_load_dwordx4 a[52:55], v8, s[12:15], s44 offen offset:512 nt
    v_add_f32 v20, v20, v21
    v_mov_b32 v21, v20
    s_nop 1
    v_permlane32_swap_b32 v20, v21
    v_add_f32 v20, v20, v21
    v_cmp_ne_u32 vcc, v102, v11
    s_mov_b32 s52, vcc_lo
    v_mov_b32_dpp v21, v20 quad_perm:[1,0,3,2] row_mask:0xf bank_mask:0xf
    v_cvt_pk_bf16_f32 v28, v20, v21
    s_mov_b32 exec_lo, 0x55555555
    s_mov_b32 exec_hi, 0
    s_cmp_lg_u32 s52, 0
    s_cbranch_scc1 L_far_q
    buffer_store_dwordx2 v[28:29], v59, s[32:35], s3 offen
L_near_q:
    s_mov_b64 exec, -1
    v_bfe_u32 v2, v0, 3, 1
    v_mul_u32_u24 v2, 0x0202, v2
    v_add_u32 v2, 0x0100, v2
    v_or_b32 v4, 0x0c0c0000, v2
    v_lshlrev_b32 v2, 16, v2
    v_or_b32 v2, 0x0c0c, v2
    s_mov_b32 vcc_lo, 0xaaaaaaaa
    s_mov_b32 vcc_hi, 0xaaaaaaaa
    v_cndmask_b32 v2, v4, v2, vcc
    v_mov_b32 v4, 0x0c0c0c0c
    s_mov_b32 vcc_lo, 0x3030303
    s_mov_b32 vcc_hi, 0x3030303
    v_cndmask_b32 v52, v4, v2, vcc
    s_mov_b32 vcc_lo, 0xc0c0c0c
    s_mov_b32 vcc_hi, 0xc0c0c0c
    s_waitcnt vmcnt(6)
    buffer_load_dwordx4 a[56:59], v8, s[12:15], s44 offen offset:256 nt
    v_cndmask_b32 v53, v4, v2, vcc
    s_mov_b32 vcc_lo, 0x30303030
    s_mov_b32 vcc_hi, 0x30303030
    v_cndmask_b32 v54, v4, v2, vcc
    s_mov_b32 vcc_lo, 0xc0c0c0c0
    s_mov_b32 vcc_hi, 0xc0c0c0c0
    v_cndmask_b32 v55, v4, v2, vcc
    s_waitcnt vmcnt(6)
    buffer_load_dwordx4 a[60:63], v8, s[12:15], s44 offen offset:768 nt
    s_and_b32 s41, s2, 3
    s_mul_i32 s41, s41, 16256
    s_add_u32 s41, s41, 393216
    s_sub_u32 s44, s44, s41
    s_waitcnt vmcnt(6)
    buffer_load_dwordx4 a[64:67], v9, s[16:19], s44 offen nt
    s_bfe_u32 s54, s2, 0x30003
    s_lshl_b32 s54, s54, 2
    s_lshl_b32 s54, s54, 11
    s_add_u32 s54, s54, 1249280
    s_and_b32 s41, s2, 7
    s_lshr_b32 s53, s2, 6
    s_lshl3_add_u32 s41, s53, s41
    v_cmp_eq_u32 s[58:59], s41, v0
    s_nop 1
    v_cndmask_b32 v7, v5, v59, s[58:59]
    v_cmp_gt_u32 s[58:59], 32, v1
    s_nop 1
    v_cndmask_b32 v6, v5, v59, s[58:59]
    v_add_u32 v6, s54, v6
    v_mov_b32 v101, s43
    s_lshl_b32 s51, s51, 2
    s_lshr_b32 s51, 0x16370405, s51
    s_and_b32 s51, s51, 15
    s_lshl1_add_u32 s51, s51, -6
    s_lshl2_add_u32 s41, s41, s42
    s_cmp_eq_u32 s41, 53
    s_cselect_b32 s58, 0xff, 0
    s_mov_b32 s59, 0
    v_lshlrev_b32 v235, 13, v1
    v_add_u32 v235, 1246464, v235
    v_cndmask_b32 v234, v5, v235, s[58:59]
    s_bfe_u32 s68, s2, 0x30003
    s_lshl_b32 s68, 1, s68
    s_and_b32 s58, s58, s68
    v_cndmask_b32 v233, v5, v235, s[58:59]
    v_cndmask_b32 v234, v234, v5, s[58:59]
    s_mov_b32 s68, 0
    buffer_load_dword v100, v6, s[32:35], 0 offen offset:0
    buffer_store_dword v101, v7, s[32:35], s54 offen offset:0
    s_addk_i32 s44, 0x4000
    s_waitcnt vmcnt(8)
    buffer_load_dwordx4 a[68:71], v9, s[16:19], s44 offen nt
    s_addk_i32 s44, 0x4000
    s_waitcnt vmcnt(8)
    buffer_load_dwordx4 a[72:75], v9, s[16:19], s44 offen nt
    s_addk_i32 s44, 0x4000
    s_waitcnt vmcnt(8)
    buffer_load_dwordx4 a[76:79], v9, s[16:19], s44 offen nt
    s_add_u32 s44, s44, 81920
    s_waitcnt vmcnt(7)
    buffer_load_dwordx4 a[80:83], v9, s[16:19], s44 offen nt
    s_addk_i32 s44, 0x4000
    s_waitcnt vmcnt(7)
    buffer_load_dwordx4 a[84:87], v9, s[16:19], s44 offen nt
    s_addk_i32 s44, 0x4000
    s_waitcnt vmcnt(7)
    buffer_load_dwordx4 a[88:91], v9, s[16:19], s44 offen nt
    s_addk_i32 s44, 0x4000
    s_waitcnt vmcnt(5)
    buffer_load_dwordx4 a[92:95], v9, s[16:19], s44 offen nt
    s_add_u32 s44, s44, 81920
    s_waitcnt vmcnt(4)
    buffer_load_dwordx4 a[96:99], v9, s[16:19], s44 offen nt
    v_cmp_eq_u32 s[58:59], v101, v100
    s_bcnt1_i32_b32 s53, s58
    s_mul_i32 s53, s53, 717
    s_sub_i32 s53, s53, 12189
    s_lshl_b32 s58, s51, 8
    s_add_i32 s58, s58, s68
    s_mul_i32 s58, s58, 28
    s_ashr_i32 s58, s58, 5
    s_add_i32 s53, s53, s58
    s_ashr_i32 s53, s53, 8
    s_addk_i32 s44, 0x4000
    s_cmp_gt_i32 s53, 0
    s_cbranch_scc1 L_cw1
    s_waitcnt vmcnt(4)
L_cw1:
    buffer_load_dwordx4 a[100:103], v9, s[16:19], s44 offen nt
    s_addk_i32 s44, 0x4000
    s_cmp_gt_i32 s53, 1
    s_cbranch_scc1 L_cw2
    s_waitcnt vmcnt(4)
L_cw2:
    buffer_load_dwordx4 a[104:107], v9, s[16:19], s44 offen nt
    s_addk_i32 s44, 0x4000
    s_cmp_gt_i32 s53, 2
    s_cbranch_scc1 L_cw3
    s_waitcnt vmcnt(4)
L_cw3:
    s_waitcnt vmcnt(6)
    buffer_load_dwordx4 a[108:111], v9, s[16:19], s44 offen nt
    s_add_u32 s44, s44, 81920
    s_cmp_gt_i32 s53, 3
    s_cbranch_scc1 L_cw4
    s_waitcnt vmcnt(4)
L_cw4:
    s_waitcnt vmcnt(6)
    buffer_load_dwordx4 a[112:115], v9, s[16:19], s44 offen nt
    s_addk_i32 s44, 0x4000
    s_cmp_gt_i32 s53, 4
    s_cbranch_scc1 L_cw5
    s_waitcnt vmcnt(4)
L_cw5:
    s_waitcnt vmcnt(6)
    buffer_load_dwordx4 a[116:119], v9, s[16:19], s44 offen nt
    s_addk_i32 s44, 0x4000
    s_cmp_gt_i32 s53, 5
    s_cbranch_scc1 L_cw6
    s_waitcnt vmcnt(4)
L_cw6:
    s_waitcnt vmcnt(6)
    buffer_load_dwordx4 a[120:123], v9, s[16:19], s44 offen nt
    s_addk_i32 s44, 0x4000
    s_cmp_gt_i32 s53, 6
    s_cbranch_scc1 L_cw7
    s_waitcnt vmcnt(4)
L_cw7:
    s_waitcnt vmcnt(6)
    buffer_load_dwordx4 a[124:127], v9, s[16:19], s44 offen nt
    s_lshr_b32 s44, s2, 2
    s_lshl_b32 s44, s44, 21
    s_and_b32 s41, s2, 3
    s_lshl_b32 s41, s41, 14
    s_add_u32 s44, s44, s41
    s_cmp_gt_i32 s53, 7
    s_cbranch_scc1 L_cw8
    s_waitcnt vmcnt(4)
L_cw8:
    s_waitcnt vmcnt(6)
    buffer_load_dwordx4 a[128:131], v8, s[20:23], s44 offen nt
    s_cmp_gt_i32 s53, 8
    s_cbranch_scc1 L_cw9
    s_waitcnt vmcnt(4)
L_cw9:
    s_waitcnt vmcnt(6)
    s_barrier
    buffer_load_dwordx4 a[132:135], v8, s[20:23], s44 offen offset:512 nt
    v_lshrrev_b32 v152, 2, v1
    v_lshlrev_b32 v152, 5, v152
    v_bfe_u32 v2, v1, 1, 1
    v_lshl_add_u32 v153, v2, 10, v152
    s_lshr_b32 s60, s2, 2
    s_lshl_b32 s60, s60, 10
    s_add_u32 s60, s60, 65536
    s_lshr_b32 s61, s2, 3
    s_lshl_b32 s61, s61, 11
    s_add_u32 s61, s61, 131072
    s_cmp_lg_u32 s52, 0
    s_cbranch_scc1 L_far_q0
    buffer_load_dwordx4 v[60:63], v152, s[32:35], s60 offen offset:0
L_near_q0:
    s_cmp_gt_i32 s53, 9
    s_cbranch_scc1 L_cw10
    s_waitcnt vmcnt(5)
L_cw10:
    s_waitcnt vmcnt(7)
    s_barrier
    buffer_load_dwordx4 a[136:139], v8, s[20:23], s44 offen offset:256 nt
    s_cmp_lg_u32 s52, 0
    s_cbranch_scc1 L_far_q1
    buffer_load_dwordx4 v[64:67], v152, s[32:35], s60 offen offset:16
L_near_q1:
    s_cmp_lg_u32 s52, 0
    s_cbranch_scc1 L_far_q2
    buffer_load_dwordx4 v[68:71], v152, s[32:35], s60 offen offset:512
L_near_q2:
    s_cmp_gt_i32 s53, 10
    s_cbranch_scc1 L_cw11
    s_waitcnt vmcnt(7)
L_cw11:
    s_waitcnt vmcnt(9)
    s_barrier
    buffer_load_dwordx4 a[140:143], v8, s[20:23], s44 offen offset:768 nt
    s_cmp_lg_u32 s52, 0
    s_cbranch_scc1 L_far_q3
    buffer_load_dwordx4 v[72:75], v152, s[32:35], s60 offen offset:528
L_near_q3:
    s_cmp_lg_u32 s52, 0
    s_cbranch_scc1 L_far_q4
    buffer_load_dwordx4 v[76:79], v153, s[32:35], s61 offen offset:0
L_near_q4:
    s_add_u32 s44, s44, 0x10000
    s_cmp_gt_i32 s53, 11
    s_cbranch_scc1 L_cw12
    s_waitcnt vmcnt(9)
L_cw12:
    s_waitcnt vmcnt(11)
    s_barrier
    buffer_load_dwordx4 a[144:147], v8, s[20:23], s44 offen nt
    s_cmp_lg_u32 s52, 0
    s_cbranch_scc1 L_far_q5
    buffer_load_dwordx4 v[80:83], v153, s[32:35], s61 offen offset:16
L_near_q5:
    s_cmp_lg_u32 s52, 0
    s_cbranch_scc1 L_far_q6
    buffer_load_dwordx4 v[84:87], v153, s[32:35], s61 offen offset:512
L_near_q6:
    s_cmp_gt_i32 s53, 12
    s_cbranch_scc1 L_cw13
    s_waitcnt vmcnt(11)
L_cw13:
    s_waitcnt vmcnt(13)
    s_barrier
    buffer_load_dwordx4 a[148:151], v8, s[20:23], s44 offen offset:512 nt
    s_cmp_lg_u32 s52, 0
    s_cbranch_scc1 L_far_q7
    buffer_load_dwordx4 v[88:91], v153, s[32:35], s61 offen offset:528
L_near_q7:
    s_cmp_gt_i32 s53, 13
    s_cbranch_scc1 L_cw14
    s_waitcnt vmcnt(12)
L_cw14:
    s_waitcnt vmcnt(14)
    s_barrier
    buffer_load_dwordx4 a[152:155], v8, s[20:23], s44 offen offset:256 nt
    s_cmp_gt_i32 s53, 14
    s_cbranch_scc1 L_cw15
    s_waitcnt vmcnt(11)
L_cw15:
    s_waitcnt vmcnt(14)
    s_barrier
    buffer_load_dwordx4 a[156:159], v8, s[20:23], s44 offen offset:768 nt
    s_add_u32 s44, s44, 0x10000
    s_cmp_gt_i32 s53, 15
    s_cbranch_scc1 L_cw16
    s_waitcnt vmcnt(9)
L_cw16:
    s_waitcnt vmcnt(14)
    s_barrier
    buffer_load_dwordx4 a[160:163], v8, s[20:23], s44 offen nt
    s_cmp_gt_i32 s53, 16
    s_cbranch_scc1 L_cw17
    s_waitcnt vmcnt(7)
L_cw17:
    s_waitcnt vmcnt(13)
    s_barrier
    buffer_load_dwordx4 a[164:167], v8, s[20:23], s44 offen offset:512 nt
    s_cmp_gt_i32 s53, 17
    s_cbranch_scc1 L_cw18
    s_waitcnt vmcnt(5)
L_cw18:
    s_waitcnt vmcnt(11)
    s_barrier
    buffer_load_dwordx4 a[168:171], v8, s[20:23], s44 offen offset:256 nt
    s_cmp_gt_i32 s53, 18
    s_cbranch_scc1 L_cw19
    s_waitcnt vmcnt(4)
L_cw19:
    s_waitcnt vmcnt(9)
    s_barrier
    buffer_load_dwordx4 a[172:175], v8, s[20:23], s44 offen offset:768 nt
    s_add_u32 s44, s44, 0x10000
    s_cmp_gt_i32 s53, 19
    s_cbranch_scc1 L_cw20
    s_waitcnt vmcnt(4)
L_cw20:
    s_waitcnt vmcnt(7)
    s_barrier
    buffer_load_dwordx4 a[176:179], v8, s[20:23], s44 offen nt
    buffer_load_dword v100, v6, s[32:35], 0 offen offset:128
    buffer_store_dword v101, v7, s[32:35], s54 offen offset:128
    buffer_store_dword v101, v233, s[32:35], 0 offen offset:2048 sc1
    s_cmp_gt_i32 s53, 20
    s_cbranch_scc1 L_cw21
    s_waitcnt vmcnt(7)
L_cw21:
    s_waitcnt vmcnt(9)
    s_barrier
    buffer_load_dwordx4 a[180:183], v8, s[20:23], s44 offen offset:512 nt
    buffer_load_dword v235, v234, s[32:35], 0 offen offset:2048 sc1
    v_bitop3_b32 v2, v61, v63, s43 bitop3:0x7e
    v_bitop3_b32 v3, v65, v67, s43 bitop3:0x7e
    v_bitop3_b32 v4, v69, v71, s43 bitop3:0x7e
    v_or3_b32 v2, v2, v3, v4
    v_bitop3_b32 v3, v73, v75, s43 bitop3:0x7e
    v_bitop3_b32 v4, v77, v79, s43 bitop3:0x7e
    v_or3_b32 v2, v2, v3, v4
    s_cmp_gt_i32 s53, 21
    s_cbranch_scc1 L_cw22
    s_waitcnt vmcnt(8)
L_cw22:
    s_waitcnt vmcnt(10)
    s_barrier
    buffer_load_dwordx4 a[184:187], v8, s[20:23], s44 offen offset:256 nt
    v_bitop3_b32 v3, v81, v83, s43 bitop3:0x7e
    v_bitop3_b32 v4, v85, v87, s43 bitop3:0x7e
    v_or3_b32 v2, v2, v3, v4
    v_bitop3_b32 v3, v89, v91, s43 bitop3:0x7e
    v_or_b32 v2, v2, v3
    v_cmp_ne_u32 vcc, 0, v2
    s_cbranch_vccnz L_slow_q
L_back_q:
    s_mov_b32 vcc_lo, 0x11111111
    s_mov_b32 vcc_hi, 0x11111111
    v_cndmask_b32 v104, 0, v60, vcc
    v_cndmask_b32 v105, 0, v62, vcc
    v_cndmask_b32 v106, 0, v64, vcc
    v_cndmask_b32 v107, 0, v66, vcc
    v_cndmask_b32 v120, 0, v68, vcc
    v_cndmask_b32 v121, 0, v70, vcc
    v_cndmask_b32 v122, 0, v72, vcc
    v_cndmask_b32 v123, 0, v74, vcc
    s_mov_b32 vcc_lo, 0x22222222
    s_mov_b32 vcc_hi, 0x22222222
    v_cndmask_b32 v108, 0, v60, vcc
    v_cndmask_b32 v109, 0, v62, vcc
    v_cndmask_b32 v110, 0, v64, vcc
    v_cndmask_b32 v111, 0, v66, vcc
    v_cndmask_b32 v124, 0, v68, vcc
    v_cndmask_b32 v125, 0, v70, vcc
    s_cmp_gt_i32 s53, 22
    s_cbranch_scc1 L_cw23
    s_waitcnt vmcnt(8)
L_cw23:
    s_waitcnt vmcnt(10)
    s_barrier
    buffer_load_dwordx4 a[188:191], v8, s[20:23], s44 offen offset:768 nt
    v_cndmask_b32 v126, 0, v72, vcc
    v_cndmask_b32 v127, 0, v74, vcc
    s_mov_b32 vcc_lo, 0x44444444
    s_mov_b32 vcc_hi, 0x44444444
    v_cndmask_b32 v112, 0, v60, vcc
    v_cndmask_b32 v113, 0, v62, vcc
    v_cndmask_b32 v114, 0, v64, vcc
    v_cndmask_b32 v115, 0, v66, vcc
    v_cndmask_b32 v128, 0, v68, vcc
    v_cndmask_b32 v129, 0, v70, vcc
    v_cndmask_b32 v130, 0, v72, vcc
    v_cndmask_b32 v131, 0, v74, vcc
    s_mov_b32 vcc_lo, 0x88888888
    s_mov_b32 vcc_hi, 0x88888888
    v_cndmask_b32 v116, 0, v60, vcc
    v_cndmask_b32 v117, 0, v62, vcc
    v_cndmask_b32 v118, 0, v64, vcc
    v_cndmask_b32 v119, 0, v66, vcc
    v_cndmask_b32 v132, 0, v68, vcc
    v_cndmask_b32 v133, 0, v70, vcc
    v_cndmask_b32 v134, 0, v72, vcc
    v_cndmask_b32 v135, 0, v74, vcc
    s_mov_b32 vcc_lo, 0x55555555
    s_mov_b32 vcc_hi, 0x55555555
    v_cndmask_b32 v136, 0, v76, vcc
    s_add_u32 s44, s44, 0x10000
    s_cmp_gt_i32 s53, 23
    s_cbranch_scc1 L_cw24
    s_waitcnt vmcnt(8)
L_cw24:
    s_waitcnt vmcnt(10)
    s_barrier
    buffer_load_dwordx4 a[192:195], v8, s[20:23], s44 offen nt
    v_cndmask_b32 v137, 0, v78, vcc
    v_cndmask_b32 v138, 0, v80, vcc
    v_cndmask_b32 v139, 0, v82, vcc
    v_cndmask_b32 v144, 0, v84, vcc
    v_cndmask_b32 v145, 0, v86, vcc
    v_cndmask_b32 v146, 0, v88, vcc
    v_cndmask_b32 v147, 0, v90, vcc
    s_mov_b32 vcc_lo, 0xaaaaaaaa
    s_mov_b32 vcc_hi, 0xaaaaaaaa
    v_cndmask_b32 v140, 0, v76, vcc
    v_cndmask_b32 v141, 0, v78, vcc
    v_cndmask_b32 v142, 0, v80, vcc
    v_cndmask_b32 v143, 0, v82, vcc
    v_cndmask_b32 v148, 0, v84, vcc
    v_cndmask_b32 v149, 0, v86, vcc
    v_cndmask_b32 v150, 0, v88, vcc
    v_cndmask_b32 v151, 0, v90, vcc
    v_mfma_f32_16x16x32_bf16 v[20:23], a[0:3], v[136:139], 0
    v_mfma_f32_16x16x32_bf16 v[20:23], a[4:7], v[140:143], v[20:23]
    s_cmp_gt_i32 s53, 24
    s_cbranch_scc1 L_cw25
    s_waitcnt vmcnt(8)
L_cw25:
    s_waitcnt vmcnt(10)
    s_barrier
    buffer_load_dwordx4 a[196:199], v8, s[20:23], s44 offen offset:512 nt
    v_mfma_f32_16x16x32_bf16 v[156:159], a[128:131], v[104:107], 0
    v_mfma_f32_16x16x32_bf16 v[20:23], a[8:11], v[144:147], v[20:23]
    v_mfma_f32_16x16x32_bf16 v[20:23], a[12:15], v[148:151], v[20:23]
    v_mfma_f32_16x16x32_bf16 v[24:27], a[16:19], v[136:139], 0
    v_mfma_f32_16x16x32_bf16 v[24:27], a[20:23], v[140:143], v[24:27]
    v_mfma_f32_16x16x32_bf16 v[24:27], a[24:27], v[144:147], v[24:27]
    v_mfma_f32_16x16x32_bf16 v[24:27], a[28:31], v[148:151], v[24:27]
    s_cmp_gt_i32 s53, 25
    s_cbranch_scc1 L_cw26
    s_waitcnt vmcnt(5)
L_cw26:
    s_waitcnt vmcnt(10)
    s_barrier
    buffer_load_dwordx4 a[200:203], v8, s[20:23], s44 offen offset:256 nt
    v_mfma_f32_16x16x32_bf16 v[160:163], a[132:135], v[104:107], 0
    v_mfma_f32_16x16x32_bf16 v[28:31], a[32:35], v[136:139], 0
    v_mfma_f32_16x16x32_bf16 v[28:31], a[36:39], v[140:143], v[28:31]
    v_mfma_f32_16x16x32_bf16 v[28:31], a[40:43], v[144:147], v[28:31]
    v_mfma_f32_16x16x32_bf16 v[28:31], a[44:47], v[148:151], v[28:31]
    v_mfma_f32_16x16x32_bf16 v[32:35], a[48:51], v[136:139], 0
    v_mfma_f32_16x16x32_bf16 v[32:35], a[52:55], v[140:143], v[32:35]
    s_cmp_gt_i32 s53, 26
    s_cbranch_scc1 L_cw27
    s_waitcnt vmcnt(4)
L_cw27:
    s_waitcnt vmcnt(10)
    s_barrier
    buffer_load_dwordx4 a[204:207], v8, s[20:23], s44 offen offset:768 nt
    v_mfma_f32_16x16x32_bf16 v[156:159], a[136:139], v[120:123], v[156:159]
    v_mfma_f32_16x16x32_bf16 v[32:35], a[56:59], v[144:147], v[32:35]
    v_mfma_f32_16x16x32_bf16 v[32:35], a[60:63], v[148:151], v[32:35]
    v_add_f32_dpp v2, v21, v20 row_ror:12 row_mask:0xf bank_mask:0xf
    v_add_f32_dpp v2, v22, v2 row_ror:8 row_mask:0xf bank_mask:0xf
    v_add_f32_dpp v103, v23, v2 row_ror:4 row_mask:0xf bank_mask:0x1
    v_add_f32_dpp v2, v24, v25 row_ror:4 row_mask:0xf bank_mask:0xf
    v_add_f32_dpp v2, v26, v2 row_ror:12 row_mask:0xf bank_mask:0xf
    v_add_f32_dpp v103, v27, v2 row_ror:8 row_mask:0xf bank_mask:0x2
    v_add_f32_dpp v2, v28, v30 row_ror:8 row_mask:0xf bank_mask:0xf
    s_add_u32 s44, s44, 0x10000
    s_cmp_gt_i32 s53, 27
    s_cbranch_scc1 L_cw28
    s_waitcnt vmcnt(4)
L_cw28:
    s_waitcnt vmcnt(7)
    s_barrier
    buffer_load_dwordx4 a[208:211], v8, s[20:23], s44 offen nt
    v_cmp_eq_u32 s[58:59], v101, v100
    s_bcnt1_i32_b32 s53, s58
    s_mul_i32 s53, s53, 819
    s_sub_i32 s53, s53, 13923
    s_lshl_b32 s58, s51, 8
    s_add_i32 s58, s58, s68
    s_mul_i32 s58, s58, 32
    s_ashr_i32 s58, s58, 5
    s_add_i32 s53, s53, s58
    s_ashr_i32 s53, s53, 8
    v_mfma_f32_16x16x32_bf16 v[160:163], a[140:143], v[120:123], v[160:163]
    v_add_f32_dpp v2, v29, v2 row_ror:4 row_mask:0xf bank_mask:0xf
    v_add_f32_dpp v103, v31, v2 row_ror:12 row_mask:0xf bank_mask:0x4
    v_add_f32_dpp v2, v32, v35 row_ror:12 row_mask:0xf bank_mask:0xf
    v_add_f32_dpp v2, v33, v2 row_ror:8 row_mask:0xf bank_mask:0xf
    v_add_f32_dpp v103, v34, v2 row_ror:4 row_mask:0xf bank_mask:0x8
    s_cmp_gt_i32 s53, 0
    s_cbranch_scc1 L_cw29
    s_waitcnt vmcnt(4)
L_cw29:
    s_waitcnt vmcnt(6)
    s_barrier
    buffer_load_dwordx4 a[212:215], v8, s[20:23], s44 offen offset:512 nt
    v_cmp_eq_u32 s[58:59], v101, v235
    s_bcnt1_i32_b32 s58, s58
    s_nop 0
    v_add_u32 v235, s58, v101
    buffer_store_dword v235, v233, s[32:35], 0 offen offset:0
    v_mfma_f32_16x16x32_bf16 v[156:159], a[144:147], v[108:111], v[156:159]
    v_cvt_pk_bf16_f32 v103, v103, v103
    v_lshlrev_b32 v2, 4, v0
    v_lshrrev_b32 v154, v2, s43
    v_mov_b32 v2, 0xffff
    v_bfi_b32 v103, v2, v154, v103
    v_mfma_f32_16x16x32_bf16 v[160:163], a[148:151], v[108:111], v[160:163]
    s_cmp_gt_i32 s53, 1
    s_cbranch_scc1 L_cw30
    s_waitcnt vmcnt(5)
L_cw30:
    s_waitcnt vmcnt(7)
    s_barrier
    buffer_load_dwordx4 a[216:219], v8, s[20:23], s44 offen offset:256 nt
    v_mfma_f32_16x16x32_bf16 v[156:159], a[152:155], v[124:127], v[156:159]
    v_mfma_f32_16x16x32_bf16 v[160:163], a[156:159], v[124:127], v[160:163]
    s_cmp_gt_i32 s53, 2
    s_cbranch_scc1 L_cw31
    s_waitcnt vmcnt(5)
L_cw31:
    s_waitcnt vmcnt(7)
    s_barrier
    buffer_load_dwordx4 a[220:223], v8, s[20:23], s44 offen offset:768 nt
    v_mfma_f32_16x16x32_bf16 v[156:159], a[160:163], v[112:115], v[156:159]
    v_mfma_f32_16x16x32_bf16 v[160:163], a[164:167], v[112:115], v[160:163]
    s_add_u32 s44, s44, 0x10000
    s_cmp_gt_i32 s53, 3
    s_cbranch_scc1 L_cw32
    s_waitcnt vmcnt(5)
L_cw32:
    s_waitcnt vmcnt(7)
    s_barrier
    buffer_load_dwordx4 a[224:227], v8, s[20:23], s44 offen nt
    v_mfma_f32_16x16x32_bf16 v[156:159], a[168:171], v[128:131], v[156:159]
    v_mfma_f32_16x16x32_bf16 v[160:163], a[172:175], v[128:131], v[160:163]
    s_cmp_gt_i32 s53, 4
    s_cbranch_scc1 L_cw33
    s_waitcnt vmcnt(5)
L_cw33:
    s_waitcnt vmcnt(7)
    s_barrier
    buffer_load_dwordx4 a[228:231], v8, s[20:23], s44 offen offset:512 nt
    v_mfma_f32_16x16x32_bf16 v[156:159], a[176:179], v[116:119], v[156:159]
    v_mfma_f32_16x16x32_bf16 v[160:163], a[180:183], v[116:119], v[160:163]
    s_cmp_gt_i32 s53, 5
    s_cbranch_scc1 L_cw34
    s_waitcnt vmcnt(5)
L_cw34:
    s_waitcnt vmcnt(7)
    s_barrier
    buffer_load_dwordx4 a[232:235], v8, s[20:23], s44 offen offset:256 nt
    v_mfma_f32_16x16x32_bf16 v[156:159], a[184:187], v[132:135], v[156:159]
    v_mfma_f32_16x16x32_bf16 v[160:163], a[188:191], v[132:135], v[160:163]
    s_cmp_gt_i32 s53, 6
    s_cbranch_scc1 L_cw35
    s_waitcnt vmcnt(4)
L_cw35:
    s_waitcnt vmcnt(7)
    s_barrier
    buffer_load_dwordx4 a[236:239], v8, s[20:23], s44 offen offset:768 nt
    v_mfma_f32_16x16x32_bf16 v[164:167], a[192:195], v[104:107], 0
    v_mfma_f32_16x16x32_bf16 v[168:171], a[196:199], v[104:107], 0
    s_add_u32 s44, s44, 0x10000
    s_cmp_gt_i32 s53, 7
    s_cbranch_scc1 L_cw36
    s_waitcnt vmcnt(4)
L_cw36:
    s_waitcnt vmcnt(7)
    s_barrier
    buffer_load_dwordx4 a[240:243], v8, s[20:23], s44 offen nt
    v_mfma_f32_16x16x32_bf16 v[164:167], a[200:203], v[120:123], v[164:167]
    v_add_f32_dpp v12, v157, v156 row_ror:12 row_mask:0xf bank_mask:0xf
    v_add_f32_dpp v12, v158, v12 row_ror:8 row_mask:0xf bank_mask:0xf
    v_add_f32_dpp v204, v159, v12 row_ror:4 row_mask:0xf bank_mask:0x1
    v_add_f32_dpp v12, v161, v160 row_ror:12 row_mask:0xf bank_mask:0xf
    v_add_f32_dpp v12, v162, v12 row_ror:8 row_mask:0xf bank_mask:0xf
    v_add_f32_dpp v205, v163, v12 row_ror:4 row_mask:0xf bank_mask:0x1
    v_mfma_f32_16x16x32_bf16 v[168:171], a[204:207], v[120:123], v[168:171]
    s_cmp_gt_i32 s53, 8
    s_cbranch_scc1 L_cw37
    s_waitcnt vmcnt(4)
L_cw37:
    s_waitcnt vmcnt(6)
    s_barrier
    buffer_load_dwordx4 a[244:247], v8, s[20:23], s44 offen offset:512 nt
    v_mfma_f32_16x16x32_bf16 v[164:167], a[208:211], v[108:111], v[164:167]
    v_mfma_f32_16x16x32_bf16 v[168:171], a[212:215], v[108:111], v[168:171]
    s_cmp_gt_i32 s53, 9
    s_cbranch_scc1 L_cw38
    s_waitcnt vmcnt(4)
L_cw38:
    s_waitcnt vmcnt(6)
    s_barrier
    buffer_load_dwordx4 a[248:251], v8, s[20:23], s44 offen offset:256 nt
    v_mfma_f32_16x16x32_bf16 v[164:167], a[216:219], v[124:127], v[164:167]
    v_mfma_f32_16x16x32_bf16 v[168:171], a[220:223], v[124:127], v[168:171]
    s_cmp_gt_i32 s53, 10
    s_cbranch_scc1 L_cw39
    s_waitcnt vmcnt(4)
L_cw39:
    s_waitcnt vmcnt(6)
    s_barrier
    buffer_load_dwordx4 a[252:255], v8, s[20:23], s44 offen offset:768 nt
    v_mfma_f32_16x16x32_bf16 v[164:167], a[224:227], v[112:115], v[164:167]
    s_add_u32 s44, s44, 0x10000
    s_cmp_gt_i32 s53, 11
    s_cbranch_scc1 L_cw40
    s_waitcnt vmcnt(4)
L_cw40:
    s_waitcnt vmcnt(6)
    s_barrier
    buffer_load_dwordx4 a[128:131], v8, s[20:23], s44 offen nt
    v_mfma_f32_16x16x32_bf16 v[168:171], a[228:231], v[112:115], v[168:171]
    s_cmp_gt_i32 s53, 12
    s_cbranch_scc1 L_cw41
    s_waitcnt vmcnt(4)
L_cw41:
    s_waitcnt vmcnt(6)
    s_barrier
    buffer_load_dwordx4 a[132:135], v8, s[20:23], s44 offen offset:512 nt
    v_mfma_f32_16x16x32_bf16 v[164:167], a[232:235], v[128:131], v[164:167]
    s_cmp_gt_i32 s53, 13
    s_cbranch_scc1 L_cw42
    s_waitcnt vmcnt(4)
L_cw42:
    s_waitcnt vmcnt(6)
    s_barrier
    buffer_load_dwordx4 a[136:139], v8, s[20:23], s44 offen offset:256 nt
    v_mfma_f32_16x16x32_bf16 v[168:171], a[236:239], v[128:131], v[168:171]
    s_cmp_gt_i32 s53, 14
    s_cbranch_scc1 L_cw43
    s_waitcnt vmcnt(4)
L_cw43:
    s_waitcnt vmcnt(6)
    s_barrier
    buffer_load_dwordx4 a[140:143], v8, s[20:23], s44 offen offset:768 nt
    v_mfma_f32_16x16x32_bf16 v[164:167], a[240:243], v[116:119], v[164:167]
    s_add_u32 s44, s44, 0x10000
    s_cmp_gt_i32 s53, 15
    s_cbranch_scc1 L_cw44
    s_waitcnt vmcnt(4)
L_cw44:
    s_waitcnt vmcnt(6)
    s_barrier
    buffer_load_dwordx4 a[144:147], v8, s[20:23], s44 offen nt
    v_mfma_f32_16x16x32_bf16 v[168:171], a[244:247], v[116:119], v[168:171]
    s_cmp_gt_i32 s53, 16
    s_cbranch_scc1 L_cw45
    s_waitcnt vmcnt(4)
L_cw45:
    s_waitcnt vmcnt(6)
    s_barrier
    buffer_load_dwordx4 a[0:3], v8, s[20:23], s44 offen offset:512 nt
    v_mfma_f32_16x16x32_bf16 v[164:167], a[248:251], v[132:135], v[164:167]
    s_cmp_gt_i32 s53, 17
    s_cbranch_scc1 L_cw46
    s_waitcnt vmcnt(4)
L_cw46:
    s_waitcnt vmcnt(6)
    s_barrier
    buffer_load_dwordx4 a[4:7], v8, s[20:23], s44 offen offset:256 nt
    v_mfma_f32_16x16x32_bf16 v[168:171], a[252:255], v[132:135], v[168:171]
    s_cmp_gt_i32 s53, 18
    s_cbranch_scc1 L_cw47
    s_waitcnt vmcnt(4)
L_cw47:
    s_waitcnt vmcnt(6)
    s_barrier
    buffer_load_dwordx4 a[8:11], v8, s[20:23], s44 offen offset:768 nt
    v_mfma_f32_16x16x32_bf16 v[156:159], a[128:131], v[104:107], 0
    s_add_u32 s44, s44, 0x10000
    s_cmp_gt_i32 s53, 19
    s_cbranch_scc1 L_cw48
    s_waitcnt vmcnt(4)
L_cw48:
    s_waitcnt vmcnt(6)
    s_barrier
    buffer_load_dwordx4 a[12:15], v8, s[20:23], s44 offen nt
    v_mfma_f32_16x16x32_bf16 v[160:163], a[132:135], v[104:107], 0
    s_cmp_gt_i32 s53, 20
    s_cbranch_scc1 L_cw49
    s_waitcnt vmcnt(4)
L_cw49:
    s_waitcnt vmcnt(6)
    s_barrier
    buffer_load_dwordx4 a[16:19], v8, s[20:23], s44 offen offset:512 nt
    v_mfma_f32_16x16x32_bf16 v[156:159], a[136:139], v[120:123], v[156:159]
    v_add_f32_dpp v12, v164, v165 row_ror:4 row_mask:0xf bank_mask:0xf
    v_add_f32_dpp v12, v166, v12 row_ror:12 row_mask:0xf bank_mask:0xf
    v_add_f32_dpp v204, v167, v12 row_ror:8 row_mask:0xf bank_mask:0x2
    v_add_f32_dpp v12, v168, v169 row_ror:4 row_mask:0xf bank_mask:0xf
    v_add_f32_dpp v12, v170, v12 row_ror:12 row_mask:0xf bank_mask:0xf
    v_add_f32_dpp v205, v171, v12 row_ror:8 row_mask:0xf bank_mask:0x2
    s_cmp_gt_i32 s53, 21
    s_cbranch_scc1 L_cw50
    s_waitcnt vmcnt(4)
L_cw50:
    s_waitcnt vmcnt(6)
    s_barrier
    buffer_load_dwordx4 a[20:23], v8, s[20:23], s44 offen offset:256 nt
    v_mfma_f32_16x16x32_bf16 v[160:163], a[140:143], v[120:123], v[160:163]
    s_cmp_gt_i32 s53, 22
    s_cbranch_scc1 L_cw51
    s_waitcnt vmcnt(4)
L_cw51:
    s_waitcnt vmcnt(6)
    s_barrier
    buffer_load_dwordx4 a[24:27], v8, s[20:23], s44 offen offset:768 nt
    v_mfma_f32_16x16x32_bf16 v[156:159], a[144:147], v[108:111], v[156:159]
    s_add_u32 s44, s44, 0x10000
    s_cmp_gt_i32 s53, 23
    s_cbranch_scc1 L_cw52
    s_waitcnt vmcnt(4)
L_cw52:
    s_waitcnt vmcnt(6)
    s_barrier
    buffer_load_dwordx4 a[28:31], v8, s[20:23], s44 offen nt
    s_and_b32 s58, s54, 0xffffe000
    s_add_u32 s58, s58, 1024
    v_writelane_b32 v6, s58, 32
    buffer_load_dword v100, v6, s[32:35], 0 offen offset:256
    buffer_store_dword v101, v7, s[32:35], s54 offen offset:256
    v_mfma_f32_16x16x32_bf16 v[160:163], a[0:3], v[108:111], v[160:163]
    s_cmp_gt_i32 s53, 24
    s_cbranch_scc1 L_cw53
    s_waitcnt vmcnt(6)
L_cw53:
    s_waitcnt vmcnt(8)
    s_barrier
    buffer_load_dwordx4 a[32:35], v8, s[20:23], s44 offen offset:512 nt
    v_mfma_f32_16x16x32_bf16 v[156:159], a[4:7], v[124:127], v[156:159]
    s_cmp_gt_i32 s53, 25
    s_cbranch_scc1 L_cw54
    s_waitcnt vmcnt(6)
L_cw54:
    s_waitcnt vmcnt(8)
    s_barrier
    buffer_load_dwordx4 a[36:39], v8, s[20:23], s44 offen offset:256 nt
    v_mfma_f32_16x16x32_bf16 v[160:163], a[8:11], v[124:127], v[160:163]
    s_cmp_gt_i32 s53, 26
    s_cbranch_scc1 L_cw55
    s_waitcnt vmcnt(6)
L_cw55:
    s_waitcnt vmcnt(8)
    s_barrier
    buffer_load_dwordx4 a[40:43], v8, s[20:23], s44 offen offset:768 nt
    v_mfma_f32_16x16x32_bf16 v[156:159], a[12:15], v[112:115], v[156:159]
    s_add_u32 s44, s44, 0x10000
    s_cmp_gt_i32 s53, 27
    s_cbranch_scc1 L_cw56
    s_waitcnt vmcnt(6)
L_cw56:
    s_waitcnt vmcnt(8)
    s_barrier
    buffer_load_dwordx4 a[44:47], v8, s[20:23], s44 offen nt
    v_mfma_f32_16x16x32_bf16 v[160:163], a[16:19], v[112:115], v[160:163]
    s_cmp_gt_i32 s53, 28
    s_cbranch_scc1 L_cw57
    s_waitcnt vmcnt(6)
L_cw57:
    s_waitcnt vmcnt(8)
    s_barrier
    buffer_load_dwordx4 a[48:51], v8, s[20:23], s44 offen offset:512 nt
    v_mfma_f32_16x16x32_bf16 v[156:159], a[20:23], v[128:131], v[156:159]
    s_cmp_gt_i32 s53, 29
    s_cbranch_scc1 L_cw58
    s_waitcnt vmcnt(4)
L_cw58:
    s_waitcnt vmcnt(8)
    s_barrier
    buffer_load_dwordx4 a[52:55], v8, s[20:23], s44 offen offset:256 nt
    v_mfma_f32_16x16x32_bf16 v[160:163], a[24:27], v[128:131], v[160:163]
    s_cmp_gt_i32 s53, 30
    s_cbranch_scc1 L_cw59
    s_waitcnt vmcnt(4)
L_cw59:
    s_waitcnt vmcnt(8)
    s_barrier
    buffer_load_dwordx4 a[56:59], v8, s[20:23], s44 offen offset:768 nt
    v_mfma_f32_16x16x32_bf16 v[156:159], a[28:31], v[116:119], v[156:159]
    s_add_u32 s44, s44, 0x10000
    s_cmp_gt_i32 s53, 31
    s_cbranch_scc1 L_cw60
    s_waitcnt vmcnt(4)
L_cw60:
    s_waitcnt vmcnt(6)
    s_barrier
    buffer_load_dwordx4 a[60:63], v8, s[20:23], s44 offen nt
    v_cmp_eq_u32 s[58:59], v101, v100
    s_bcnt1_i32_b32 s53, s58
    s_mul_i32 s53, s53, 819
    s_sub_i32 s53, s53, 13923
    v_readlane_b32 s58, v100, 32
    s_sub_u32 s58, s58, s43
    s_mul_i32 s68, s58, 1536
    s_sub_i32 s68, s68, 5376
    s_cmp_lt_u32 s58, 8
    s_cselect_b32 s68, s68, 0
    s_lshl_b32 s58, s51, 8
    s_add_i32 s58, s58, s68
    s_mul_i32 s58, s58, 32
    s_ashr_i32 s58, s58, 5
    s_add_i32 s53, s53, s58
    s_ashr_i32 s53, s53, 8
    v_mfma_f32_16x16x32_bf16 v[160:163], a[32:35], v[116:119], v[160:163]
    s_cmp_gt_i32 s53, 0
    s_cbranch_scc1 L_cw61
    s_waitcnt vmcnt(4)
L_cw61:
    s_waitcnt vmcnt(6)
    s_barrier
    buffer_load_dwordx4 a[148:151], v8, s[20:23], s44 offen offset:512 nt
    v_mfma_f32_16x16x32_bf16 v[156:159], a[36:39], v[132:135], v[156:159]
    s_cmp_gt_i32 s53, 1
    s_cbranch_scc1 L_cw62
    s_waitcnt vmcnt(4)
L_cw62:
    s_waitcnt vmcnt(6)
    s_barrier
    buffer_load_dwordx4 a[152:155], v8, s[20:23], s44 offen offset:256 nt
    v_mfma_f32_16x16x32_bf16 v[160:163], a[40:43], v[132:135], v[160:163]
    s_cmp_gt_i32 s53, 2
    s_cbranch_scc1 L_cw63
    s_waitcnt vmcnt(4)
L_cw63:
    s_waitcnt vmcnt(6)
    s_barrier
    buffer_load_dwordx4 a[156:159], v8, s[20:23], s44 offen offset:768 nt
    v_mfma_f32_16x16x32_bf16 v[164:167], a[44:47], v[104:107], 0
    s_add_u32 s44, s44, 0x10000
    s_cmp_gt_i32 s53, 3
    s_cbranch_scc1 L_cw64
    s_waitcnt vmcnt(4)
L_cw64:
    s_waitcnt vmcnt(6)
    s_barrier
    buffer_load_dwordx4 a[160:163], v8, s[20:23], s44 offen nt
    v_mfma_f32_16x16x32_bf16 v[168:171], a[48:51], v[104:107], 0
    s_cmp_gt_i32 s53, 4
    s_cbranch_scc1 L_cw65
    s_waitcnt vmcnt(4)
L_cw65:
    s_waitcnt vmcnt(6)
    s_barrier
    buffer_load_dwordx4 a[164:167], v8, s[20:23], s44 offen offset:512 nt
    v_mfma_f32_16x16x32_bf16 v[164:167], a[52:55], v[120:123], v[164:167]
    v_add_f32_dpp v12, v156, v158 row_ror:8 row_mask:0xf bank_mask:0xf
    v_add_f32_dpp v12, v157, v12 row_ror:4 row_mask:0xf bank_mask:0xf
    v_add_f32_dpp v204, v159, v12 row_ror:12 row_mask:0xf bank_mask:0x4
    v_add_f32_dpp v12, v160, v162 row_ror:8 row_mask:0xf bank_mask:0xf
    v_add_f32_dpp v12, v161, v12 row_ror:4 row_mask:0xf bank_mask:0xf
    v_add_f32_dpp v205, v163, v12 row_ror:12 row_mask:0xf bank_mask:0x4
    s_cmp_gt_i32 s53, 5
    s_cbranch_scc1 L_cw66
    s_waitcnt vmcnt(4)
L_cw66:
    s_waitcnt vmcnt(6)
    s_barrier
    buffer_load_dwordx4 a[168:171], v8, s[20:23], s44 offen offset:256 nt
    v_mfma_f32_16x16x32_bf16 v[168:171], a[56:59], v[120:123], v[168:171]
    s_cmp_gt_i32 s53, 6
    s_cbranch_scc1 L_cw67
    s_waitcnt vmcnt(4)
L_cw67:
    s_waitcnt vmcnt(6)
    s_barrier
    buffer_load_dwordx4 a[172:175], v8, s[20:23], s44 offen offset:768 nt
    v_mfma_f32_16x16x32_bf16 v[164:167], a[60:63], v[108:111], v[164:167]
    s_add_u32 s44, s44, 0x10000
    s_cmp_gt_i32 s53, 7
    s_cbranch_scc1 L_cw68
    s_waitcnt vmcnt(4)
L_cw68:
    s_waitcnt vmcnt(6)
    s_barrier
    buffer_load_dwordx4 a[176:179], v8, s[20:23], s44 offen nt
    v_mfma_f32_16x16x32_bf16 v[168:171], a[148:151], v[108:111], v[168:171]
    s_cmp_gt_i32 s53, 8
    s_cbranch_scc1 L_cw69
    s_waitcnt vmcnt(4)
L_cw69:
    s_waitcnt vmcnt(6)
    s_barrier
    buffer_load_dwordx4 a[180:183], v8, s[20:23], s44 offen offset:512 nt
    v_mfma_f32_16x16x32_bf16 v[164:167], a[152:155], v[124:127], v[164:167]
    s_cmp_gt_i32 s53, 9
    s_cbranch_scc1 L_cw70
    s_waitcnt vmcnt(4)
L_cw70:
    s_waitcnt vmcnt(6)
    s_barrier
    buffer_load_dwordx4 a[184:187], v8, s[20:23], s44 offen offset:256 nt
    v_mfma_f32_16x16x32_bf16 v[168:171], a[156:159], v[124:127], v[168:171]
    s_cmp_gt_i32 s53, 10
    s_cbranch_scc1 L_cw71
    s_waitcnt vmcnt(4)
L_cw71:
    s_waitcnt vmcnt(6)
    s_barrier
    buffer_load_dwordx4 a[188:191], v8, s[20:23], s44 offen offset:768 nt
    v_mfma_f32_16x16x32_bf16 v[164:167], a[160:163], v[112:115], v[164:167]
    s_add_u32 s44, s44, 0x10000
    s_cmp_gt_i32 s53, 11
    s_cbranch_scc1 L_cw72
    s_waitcnt vmcnt(4)
L_cw72:
    s_waitcnt vmcnt(6)
    s_barrier
    buffer_load_dwordx4 a[192:195], v8, s[20:23], s44 offen nt
    v_mfma_f32_16x16x32_bf16 v[168:171], a[164:167], v[112:115], v[168:171]
    s_cmp_gt_i32 s53, 12
    s_cbranch_scc1 L_cw73
    s_waitcnt vmcnt(4)
L_cw73:
    s_waitcnt vmcnt(6)
    s_barrier
    buffer_load_dwordx4 a[196:199], v8, s[20:23], s44 offen offset:512 nt
    v_mfma_f32_16x16x32_bf16 v[164:167], a[168:171], v[128:131], v[164:167]
    s_cmp_gt_i32 s53, 13
    s_cbranch_scc1 L_cw74
    s_waitcnt vmcnt(4)
L_cw74:
    s_waitcnt vmcnt(6)
    s_barrier
    buffer_load_dwordx4 a[200:203], v8, s[20:23], s44 offen offset:256 nt
    v_mfma_f32_16x16x32_bf16 v[168:171], a[172:175], v[128:131], v[168:171]
    s_cmp_gt_i32 s53, 14
    s_cbranch_scc1 L_cw75
    s_waitcnt vmcnt(4)
L_cw75:
    s_waitcnt vmcnt(6)
    s_barrier
    buffer_load_dwordx4 a[204:207], v8, s[20:23], s44 offen offset:768 nt
    v_mfma_f32_16x16x32_bf16 v[164:167], a[176:179], v[116:119], v[164:167]
    s_add_u32 s44, s44, 0x10000
    s_cmp_gt_i32 s53, 15
    s_cbranch_scc1 L_cw76
    s_waitcnt vmcnt(4)
L_cw76:
    s_waitcnt vmcnt(6)
    s_barrier
    buffer_load_dwordx4 a[208:211], v8, s[20:23], s44 offen nt
    v_mfma_f32_16x16x32_bf16 v[168:171], a[180:183], v[116:119], v[168:171]
    s_cmp_gt_i32 s53, 16
    s_cbranch_scc1 L_cw77
    s_waitcnt vmcnt(4)
L_cw77:
    s_waitcnt vmcnt(6)
    s_barrier
    buffer_load_dwordx4 a[212:215], v8, s[20:23], s44 offen offset:512 nt
    v_mfma_f32_16x16x32_bf16 v[164:167], a[184:187], v[132:135], v[164:167]
    s_cmp_gt_i32 s53, 17
    s_cbranch_scc1 L_cw78
    s_waitcnt vmcnt(4)
L_cw78:
    s_waitcnt vmcnt(6)
    s_barrier
    buffer_load_dwordx4 a[216:219], v8, s[20:23], s44 offen offset:256 nt
    v_mfma_f32_16x16x32_bf16 v[168:171], a[188:191], v[132:135], v[168:171]
    s_cmp_gt_i32 s53, 18
    s_cbranch_scc1 L_cw79
    s_waitcnt vmcnt(4)
L_cw79:
    s_waitcnt vmcnt(6)
    s_barrier
    buffer_load_dwordx4 a[220:223], v8, s[20:23], s44 offen offset:768 nt
    v_mfma_f32_16x16x32_bf16 v[156:159], a[192:195], v[104:107], 0
    s_add_u32 s44, s44, 0x10000
    s_cmp_gt_i32 s53, 19
    s_cbranch_scc1 L_cw80
    s_waitcnt vmcnt(4)
L_cw80:
    s_waitcnt vmcnt(6)
    s_barrier
    buffer_load_dwordx4 a[224:227], v8, s[20:23], s44 offen nt
    v_mfma_f32_16x16x32_bf16 v[160:163], a[196:199], v[104:107], 0
    s_cmp_gt_i32 s53, 20
    s_cbranch_scc1 L_cw81
    s_waitcnt vmcnt(4)
L_cw81:
    s_waitcnt vmcnt(6)
    s_barrier
    buffer_load_dwordx4 a[228:231], v8, s[20:23], s44 offen offset:512 nt
    v_mfma_f32_16x16x32_bf16 v[156:159], a[200:203], v[120:123], v[156:159]
    v_add_f32_dpp v12, v164, v167 row_ror:12 row_mask:0xf bank_mask:0xf
    v_add_f32_dpp v12, v165, v12 row_ror:8 row_mask:0xf bank_mask:0xf
    v_add_f32_dpp v204, v166, v12 row_ror:4 row_mask:0xf bank_mask:0x8
    v_add_f32_dpp v12, v168, v171 row_ror:12 row_mask:0xf bank_mask:0xf
    v_add_f32_dpp v12, v169, v12 row_ror:8 row_mask:0xf bank_mask:0xf
    v_add_f32_dpp v205, v170, v12 row_ror:4 row_mask:0xf bank_mask:0x8
    s_cmp_gt_i32 s53, 21
    s_cbranch_scc1 L_cw82
    s_waitcnt vmcnt(4)
L_cw82:
    s_waitcnt vmcnt(6)
    s_barrier
    buffer_load_dwordx4 a[232:235], v8, s[20:23], s44 offen offset:256 nt
    v_mfma_f32_16x16x32_bf16 v[160:163], a[204:207], v[120:123], v[160:163]
    s_cmp_gt_i32 s53, 22
    s_cbranch_scc1 L_cw83
    s_waitcnt vmcnt(4)
L_cw83:
    s_waitcnt vmcnt(6)
    s_barrier
    buffer_load_dwordx4 a[236:239], v8, s[20:23], s44 offen offset:768 nt
    v_mfma_f32_16x16x32_bf16 v[156:159], a[208:211], v[108:111], v[156:159]
    s_add_u32 s44, s44, 0x10000
    s_cmp_gt_i32 s53, 23
    s_cbranch_scc1 L_cw84
    s_waitcnt vmcnt(4)
L_cw84:
    s_waitcnt vmcnt(6)
    s_barrier
    buffer_load_dwordx4 a[240:243], v8, s[20:23], s44 offen nt
    v_writelane_b32 v6, 2.0, 32
    buffer_load_dword v100, v6, s[32:35], 0 offen offset:384
    buffer_store_dword v101, v7, s[32:35], s54 offen offset:384
    buffer_store_dword v101, v233, s[32:35], 0 offen offset:2176 sc1
    v_mfma_f32_16x16x32_bf16 v[160:163], a[212:215], v[108:111], v[160:163]
    s_cmp_gt_i32 s53, 24
    s_cbranch_scc1 L_cw85
    s_waitcnt vmcnt(7)
L_cw85:
    s_waitcnt vmcnt(9)
    s_barrier
    buffer_load_dwordx4 a[244:247], v8, s[20:23], s44 offen offset:512 nt
    buffer_load_dword v235, v234, s[32:35], 0 offen offset:2176 sc1
    v_mfma_f32_16x16x32_bf16 v[156:159], a[216:219], v[124:127], v[156:159]
    s_cmp_gt_i32 s53, 25
    s_cbranch_scc1 L_cw86
    s_waitcnt vmcnt(8)
L_cw86:
    s_waitcnt vmcnt(10)
    s_barrier
    buffer_load_dwordx4 a[248:251], v8, s[20:23], s44 offen offset:256 nt
    v_mfma_f32_16x16x32_bf16 v[160:163], a[220:223], v[124:127], v[160:163]
    s_cmp_gt_i32 s53, 26
    s_cbranch_scc1 L_cw87
    s_waitcnt vmcnt(8)
L_cw87:
    s_waitcnt vmcnt(10)
    s_barrier
    buffer_load_dwordx4 a[252:255], v8, s[20:23], s44 offen offset:768 nt
    v_mfma_f32_16x16x32_bf16 v[156:159], a[224:227], v[112:115], v[156:159]
    s_add_u32 s44, s44, 0x10000
    s_cmp_gt_i32 s53, 27
    s_cbranch_scc1 L_cw88
    s_waitcnt vmcnt(8)
L_cw88:
    s_waitcnt vmcnt(10)
    s_barrier
    buffer_load_dwordx4 a[128:131], v8, s[20:23], s44 offen nt
    v_mfma_f32_16x16x32_bf16 v[160:163], a[228:231], v[112:115], v[160:163]
    s_cmp_gt_i32 s53, 28
    s_cbranch_scc1 L_cw89
    s_waitcnt vmcnt(8)
L_cw89:
    s_waitcnt vmcnt(10)
    s_barrier
    buffer_load_dwordx4 a[132:135], v8, s[20:23], s44 offen offset:512 nt
    v_mfma_f32_16x16x32_bf16 v[156:159], a[232:235], v[128:131], v[156:159]
    s_cmp_gt_i32 s53, 29
    s_cbranch_scc1 L_cw90
    s_waitcnt vmcnt(5)
L_cw90:
    s_waitcnt vmcnt(10)
    s_barrier
    buffer_load_dwordx4 a[136:139], v8, s[20:23], s44 offen offset:256 nt
    v_mfma_f32_16x16x32_bf16 v[160:163], a[236:239], v[128:131], v[160:163]
    s_cmp_gt_i32 s53, 30
    s_cbranch_scc1 L_cw91
    s_waitcnt vmcnt(4)
L_cw91:
    s_waitcnt vmcnt(10)
    s_barrier
    buffer_load_dwordx4 a[140:143], v8, s[20:23], s44 offen offset:768 nt
    v_mfma_f32_16x16x32_bf16 v[156:159], a[240:243], v[116:119], v[156:159]
    s_add_u32 s44, s44, 0x10000
    s_cmp_gt_i32 s53, 31
    s_cbranch_scc1 L_cw92
    s_waitcnt vmcnt(4)
L_cw92:
    s_waitcnt vmcnt(7)
    s_barrier
    buffer_load_dwordx4 a[144:147], v8, s[20:23], s44 offen nt
    v_cmp_eq_u32 s[58:59], v101, v100
    s_bcnt1_i32_b32 s53, s58
    s_mul_i32 s53, s53, 819
    s_sub_i32 s53, s53, 13923
    s_lshl_b32 s58, s51, 8
    s_add_i32 s58, s58, s68
    s_mul_i32 s58, s58, 32
    s_ashr_i32 s58, s58, 5
    s_add_i32 s53, s53, s58
    s_ashr_i32 s53, s53, 8
    v_mfma_f32_16x16x32_bf16 v[160:163], a[244:247], v[116:119], v[160:163]
    s_cmp_gt_i32 s53, 0
    s_cbranch_scc1 L_cw93
    s_waitcnt vmcnt(4)
L_cw93:
    s_waitcnt vmcnt(6)
    s_barrier
    buffer_load_dwordx4 a[0:3], v8, s[20:23], s44 offen offset:512 nt
    v_cmp_eq_u32 s[58:59], v101, v235
    s_bcnt1_i32_b32 s58, s58
    s_nop 0
    v_add_u32 v235, s58, v101
    buffer_store_dword v235, v233, s[32:35], 0 offen offset:128
    v_mfma_f32_16x16x32_bf16 v[156:159], a[248:251], v[132:135], v[156:159]
    s_cmp_gt_i32 s53, 1
    s_cbranch_scc1 L_cw94
    s_waitcnt vmcnt(5)
L_cw94:
    s_waitcnt vmcnt(7)
    s_barrier
    buffer_load_dwordx4 a[4:7], v8, s[20:23], s44 offen offset:256 nt
    v_mfma_f32_16x16x32_bf16 v[160:163], a[252:255], v[132:135], v[160:163]
    s_cmp_gt_i32 s53, 2
    s_cbranch_scc1 L_cw95
    s_waitcnt vmcnt(5)
L_cw95:
    s_waitcnt vmcnt(7)
    s_barrier
    buffer_load_dwordx4 a[8:11], v8, s[20:23], s44 offen offset:768 nt
    v_mfma_f32_16x16x32_bf16 v[164:167], a[128:131], v[104:107], 0
    s_add_u32 s44, s44, 0x10000
    s_cmp_gt_i32 s53, 3
    s_cbranch_scc1 L_cw96
    s_waitcnt vmcnt(5)
L_cw96:
    s_waitcnt vmcnt(7)
    s_barrier
    buffer_load_dwordx4 a[12:15], v8, s[20:23], s44 offen nt
    v_mfma_f32_16x16x32_bf16 v[168:171], a[132:135], v[104:107], 0
    global_load_ubyte v102, v10, s[56:57] nt
    s_cmp_gt_i32 s53, 4
    s_cbranch_scc1 L_cw97
    s_waitcnt vmcnt(6)
L_cw97:
    s_waitcnt vmcnt(8)
    s_barrier
    buffer_load_dwordx4 a[16:19], v8, s[20:23], s44 offen offset:512 nt
    v_mfma_f32_16x16x32_bf16 v[164:167], a[136:139], v[120:123], v[164:167]
    v_add_f32_dpp v12, v157, v156 row_ror:12 row_mask:0xf bank_mask:0xf
    v_add_f32_dpp v12, v158, v12 row_ror:8 row_mask:0xf bank_mask:0xf
    v_add_f32_dpp v206, v159, v12 row_ror:4 row_mask:0xf bank_mask:0x1
    v_add_f32_dpp v12, v161, v160 row_ror:12 row_mask:0xf bank_mask:0xf
    v_add_f32_dpp v12, v162, v12 row_ror:8 row_mask:0xf bank_mask:0xf
    v_add_f32_dpp v207, v163, v12 row_ror:4 row_mask:0xf bank_mask:0x1
    s_cmp_gt_i32 s53, 5
    s_cbranch_scc1 L_cw98
    s_waitcnt vmcnt(6)
L_cw98:
    s_waitcnt vmcnt(8)
    s_barrier
    buffer_load_dwordx4 a[20:23], v8, s[20:23], s44 offen offset:256 nt
    v_mfma_f32_16x16x32_bf16 v[168:171], a[140:143], v[120:123], v[168:171]
    s_cmp_gt_i32 s53, 6
    s_cbranch_scc1 L_cw99
    s_waitcnt vmcnt(5)
L_cw99:
    s_waitcnt vmcnt(8)
    s_barrier
    buffer_load_dwordx4 a[24:27], v8, s[20:23], s44 offen offset:768 nt
    v_mfma_f32_16x16x32_bf16 v[164:167], a[144:147], v[108:111], v[164:167]
    s_add_u32 s44, s44, 0x10000
    s_cmp_gt_i32 s53, 7
    s_cbranch_scc1 L_cw100
    s_waitcnt vmcnt(5)
L_cw100:
    s_waitcnt vmcnt(8)
    s_barrier
    buffer_load_dwordx4 a[28:31], v8, s[20:23], s44 offen nt
    v_mfma_f32_16x16x32_bf16 v[168:171], a[0:3], v[108:111], v[168:171]
    s_cmp_gt_i32 s53, 8
    s_cbranch_scc1 L_cw101
    s_waitcnt vmcnt(5)
L_cw101:
    s_waitcnt vmcnt(7)
    s_barrier
    buffer_load_dwordx4 a[32:35], v8, s[20:23], s44 offen offset:512 nt
    v_mfma_f32_16x16x32_bf16 v[164:167], a[4:7], v[124:127], v[164:167]
    s_cmp_gt_i32 s53, 9
    s_cbranch_scc1 L_cw102
    s_waitcnt vmcnt(4)
L_cw102:
    s_waitcnt vmcnt(7)
    s_barrier
    buffer_load_dwordx4 a[36:39], v8, s[20:23], s44 offen offset:256 nt
    v_mfma_f32_16x16x32_bf16 v[168:171], a[8:11], v[124:127], v[168:171]
    s_cmp_gt_i32 s53, 10
    s_cbranch_scc1 L_cw103
    s_waitcnt vmcnt(4)
L_cw103:
    s_waitcnt vmcnt(7)
    s_barrier
    buffer_load_dwordx4 a[40:43], v8, s[20:23], s44 offen offset:768 nt
    v_mfma_f32_16x16x32_bf16 v[164:167], a[12:15], v[112:115], v[164:167]
    s_add_u32 s44, s44, 0x10000
    s_cmp_gt_i32 s53, 11
    s_cbranch_scc1 L_cw104
    s_waitcnt vmcnt(4)
L_cw104:
    s_waitcnt vmcnt(6)
    s_barrier
    buffer_load_dwordx4 a[44:47], v8, s[20:23], s44 offen nt
    v_mfma_f32_16x16x32_bf16 v[168:171], a[16:19], v[112:115], v[168:171]
    v_cmp_ne_u32 vcc, v102, v11
    s_mov_b32 s52, vcc_lo
    s_cmp_gt_i32 s53, 12
    s_cbranch_scc1 L_cw105
    s_waitcnt vmcnt(4)
L_cw105:
    s_waitcnt vmcnt(6)
    s_barrier
    buffer_load_dwordx4 a[48:51], v8, s[20:23], s44 offen offset:512 nt
    v_mfma_f32_16x16x32_bf16 v[164:167], a[20:23], v[128:131], v[164:167]
    s_cmp_gt_i32 s53, 13
    s_cbranch_scc1 L_cw106
    s_waitcnt vmcnt(4)
L_cw106:
    s_waitcnt vmcnt(6)
    s_barrier
    buffer_load_dwordx4 a[52:55], v8, s[20:23], s44 offen offset:256 nt
    v_mfma_f32_16x16x32_bf16 v[168:171], a[24:27], v[128:131], v[168:171]
    s_cmp_gt_i32 s53, 14
    s_cbranch_scc1 L_cw107
    s_waitcnt vmcnt(4)
L_cw107:
    s_waitcnt vmcnt(6)
    s_barrier
    buffer_load_dwordx4 a[56:59], v8, s[20:23], s44 offen offset:768 nt
    v_mfma_f32_16x16x32_bf16 v[164:167], a[28:31], v[116:119], v[164:167]
    s_add_u32 s44, s44, 0x10000
    s_cmp_gt_i32 s53, 15
    s_cbranch_scc1 L_cw108
    s_waitcnt vmcnt(4)
L_cw108:
    s_waitcnt vmcnt(6)
    s_barrier
    buffer_load_dwordx4 a[60:63], v8, s[20:23], s44 offen nt
    v_mfma_f32_16x16x32_bf16 v[168:171], a[32:35], v[116:119], v[168:171]
    s_cmp_gt_i32 s53, 16
    s_cbranch_scc1 L_cw109
    s_waitcnt vmcnt(4)
L_cw109:
    s_waitcnt vmcnt(6)
    s_barrier
    buffer_load_dwordx4 a[148:151], v8, s[20:23], s44 offen offset:512 nt
    v_mfma_f32_16x16x32_bf16 v[164:167], a[36:39], v[132:135], v[164:167]
    s_cmp_gt_i32 s53, 17
    s_cbranch_scc1 L_cw110
    s_waitcnt vmcnt(4)
L_cw110:
    s_waitcnt vmcnt(6)
    s_barrier
    buffer_load_dwordx4 a[152:155], v8, s[20:23], s44 offen offset:256 nt
    v_mfma_f32_16x16x32_bf16 v[168:171], a[40:43], v[132:135], v[168:171]
    s_cmp_gt_i32 s53, 18
    s_cbranch_scc1 L_cw111
    s_waitcnt vmcnt(4)
L_cw111:
    s_waitcnt vmcnt(6)
    s_barrier
    buffer_load_dwordx4 a[156:159], v8, s[20:23], s44 offen offset:768 nt
    v_mfma_f32_16x16x32_bf16 v[156:159], a[44:47], v[104:107], 0
    s_add_u32 s44, s44, 0x10000
    s_cmp_gt_i32 s53, 19
    s_cbranch_scc1 L_cw112
    s_waitcnt vmcnt(4)
L_cw112:
    s_waitcnt vmcnt(6)
    s_barrier
    buffer_load_dwordx4 a[160:163], v8, s[20:23], s44 offen nt
    v_mfma_f32_16x16x32_bf16 v[160:163], a[48:51], v[104:107], 0
    s_cmp_gt_i32 s53, 20
    s_cbranch_scc1 L_cw113
    s_waitcnt vmcnt(4)
L_cw113:
    s_waitcnt vmcnt(6)
    s_barrier
    buffer_load_dwordx4 a[164:167], v8, s[20:23], s44 offen offset:512 nt
    v_mfma_f32_16x16x32_bf16 v[156:159], a[52:55], v[120:123], v[156:159]
    v_add_f32_dpp v12, v164, v165 row_ror:4 row_mask:0xf bank_mask:0xf
    v_add_f32_dpp v12, v166, v12 row_ror:12 row_mask:0xf bank_mask:0xf
    v_add_f32_dpp v206, v167, v12 row_ror:8 row_mask:0xf bank_mask:0x2
    v_add_f32_dpp v12, v168, v169 row_ror:4 row_mask:0xf bank_mask:0xf
    v_add_f32_dpp v12, v170, v12 row_ror:12 row_mask:0xf bank_mask:0xf
    v_add_f32_dpp v207, v171, v12 row_ror:8 row_mask:0xf bank_mask:0x2
    s_cmp_gt_i32 s53, 21
    s_cbranch_scc1 L_cw114
    s_waitcnt vmcnt(4)
L_cw114:
    s_waitcnt vmcnt(6)
    s_barrier
    buffer_load_dwordx4 a[168:171], v8, s[20:23], s44 offen offset:256 nt
    v_mfma_f32_16x16x32_bf16 v[160:163], a[56:59], v[120:123], v[160:163]
    s_cmp_gt_i32 s53, 22
    s_cbranch_scc1 L_cw115
    s_waitcnt vmcnt(4)
L_cw115:
    s_waitcnt vmcnt(6)
    s_barrier
    buffer_load_dwordx4 a[172:175], v8, s[20:23], s44 offen offset:768 nt
    v_mfma_f32_16x16x32_bf16 v[156:159], a[60:63], v[108:111], v[156:159]
    s_add_u32 s44, s44, 0x10000
    s_cmp_gt_i32 s53, 23
    s_cbranch_scc1 L_cw116
    s_waitcnt vmcnt(4)
L_cw116:
    s_waitcnt vmcnt(6)
    s_barrier
    buffer_load_dwordx4 a[176:179], v8, s[20:23], s44 offen nt
    s_and_b32 s58, s54, 0xffffe000
    s_add_u32 s58, s58, 896
    v_writelane_b32 v6, s58, 32
    buffer_load_dword v100, v6, s[32:35], 0 offen offset:512
    buffer_store_dword v101, v7, s[32:35], s54 offen offset:512
    v_mfma_f32_16x16x32_bf16 v[160:163], a[148:151], v[108:111], v[160:163]
    s_cmp_gt_i32 s53, 24
    s_cbranch_scc1 L_cw117
    s_waitcnt vmcnt(6)
L_cw117:
    s_waitcnt vmcnt(8)
    s_barrier
    buffer_load_dwordx4 a[180:183], v8, s[20:23], s44 offen offset:512 nt
    v_mfma_f32_16x16x32_bf16 v[156:159], a[152:155], v[124:127], v[156:159]
    s_cmp_gt_i32 s53, 25
    s_cbranch_scc1 L_cw118
    s_waitcnt vmcnt(6)
L_cw118:
    s_waitcnt vmcnt(8)
    s_barrier
    buffer_load_dwordx4 a[184:187], v8, s[20:23], s44 offen offset:256 nt
    v_mfma_f32_16x16x32_bf16 v[160:163], a[156:159], v[124:127], v[160:163]
    s_cmp_gt_i32 s53, 26
    s_cbranch_scc1 L_cw119
    s_waitcnt vmcnt(6)
L_cw119:
    s_waitcnt vmcnt(8)
    s_barrier
    buffer_load_dwordx4 a[188:191], v8, s[20:23], s44 offen offset:768 nt
    v_mfma_f32_16x16x32_bf16 v[156:159], a[160:163], v[112:115], v[156:159]
    s_add_u32 s44, s44, 0x10000
    s_cmp_gt_i32 s53, 27
    s_cbranch_scc1 L_cw120
    s_waitcnt vmcnt(6)
L_cw120:
    s_waitcnt vmcnt(8)
    s_barrier
    buffer_load_dwordx4 a[192:195], v8, s[20:23], s44 offen nt
    v_mfma_f32_16x16x32_bf16 v[160:163], a[164:167], v[112:115], v[160:163]
    s_cmp_gt_i32 s53, 28
    s_cbranch_scc1 L_cw121
    s_waitcnt vmcnt(6)
L_cw121:
    s_waitcnt vmcnt(8)
    s_barrier
    buffer_load_dwordx4 a[196:199], v8, s[20:23], s44 offen offset:512 nt
    v_mfma_f32_16x16x32_bf16 v[156:159], a[168:171], v[128:131], v[156:159]
    s_cmp_gt_i32 s53, 29
    s_cbranch_scc1 L_cw122
    s_waitcnt vmcnt(4)
L_cw122:
    s_waitcnt vmcnt(8)
    s_barrier
    buffer_load_dwordx4 a[200:203], v8, s[20:23], s44 offen offset:256 nt
    v_mfma_f32_16x16x32_bf16 v[160:163], a[172:175], v[128:131], v[160:163]
    s_cmp_gt_i32 s53, 30
    s_cbranch_scc1 L_cw123
    s_waitcnt vmcnt(4)
L_cw123:
    s_waitcnt vmcnt(8)
    s_barrier
    buffer_load_dwordx4 a[204:207], v8, s[20:23], s44 offen offset:768 nt
    v_mfma_f32_16x16x32_bf16 v[156:159], a[176:179], v[116:119], v[156:159]
    s_add_u32 s44, s44, 0x10000
    s_cmp_gt_i32 s53, 31
    s_cbranch_scc1 L_cw124
    s_waitcnt vmcnt(4)
L_cw124:
    s_waitcnt vmcnt(6)
    s_barrier
    buffer_load_dwordx4 a[208:211], v8, s[20:23], s44 offen nt
    v_cmp_eq_u32 s[58:59], v101, v100
    s_bcnt1_i32_b32 s53, s58
    s_mul_i32 s53, s53, 768
    s_sub_i32 s53, s53, 13056
    v_readlane_b32 s58, v100, 32
    s_sub_u32 s58, s58, s43
    s_mul_i32 s68, s58, 1536
    s_sub_i32 s68, s68, 5376
    s_cmp_lt_u32 s58, 8
    s_cselect_b32 s68, s68, 0
    s_lshl_b32 s58, s51, 8
    s_add_i32 s58, s58, s68
    s_mul_i32 s58, s58, 30
    s_ashr_i32 s58, s58, 5
    s_add_i32 s53, s53, s58
    s_ashr_i32 s53, s53, 8
    v_mfma_f32_16x16x32_bf16 v[160:163], a[180:183], v[116:119], v[160:163]
    s_cmp_gt_i32 s53, 0
    s_cbranch_scc1 L_cw125
    s_waitcnt vmcnt(4)
L_cw125:
    s_waitcnt vmcnt(6)
    s_barrier
    buffer_load_dwordx4 a[212:215], v8, s[20:23], s44 offen offset:512 nt
    v_mfma_f32_16x16x32_bf16 v[156:159], a[184:187], v[132:135], v[156:159]
    s_cmp_gt_i32 s53, 1
    s_cbranch_scc1 L_cw126
    s_waitcnt vmcnt(4)
L_cw126:
    s_waitcnt vmcnt(6)
    s_barrier
    buffer_load_dwordx4 a[216:219], v8, s[20:23], s44 offen offset:256 nt
    v_mfma_f32_16x16x32_bf16 v[160:163], a[188:191], v[132:135], v[160:163]
    s_cmp_gt_i32 s53, 2
    s_cbranch_scc1 L_cw127
    s_waitcnt vmcnt(4)
L_cw127:
    s_waitcnt vmcnt(6)
    s_barrier
    buffer_load_dwordx4 a[220:223], v8, s[20:23], s44 offen offset:768 nt
    v_mfma_f32_16x16x32_bf16 v[164:167], a[192:195], v[104:107], 0
    s_add_u32 s44, s44, 0x10000
    s_cmp_gt_i32 s53, 3
    s_cbranch_scc1 L_cw128
    s_waitcnt vmcnt(4)
L_cw128:
    s_waitcnt vmcnt(6)
    s_barrier
    buffer_load_dwordx4 a[224:227], v8, s[20:23], s44 offen nt
    v_mfma_f32_16x16x32_bf16 v[168:171], a[196:199], v[104:107], 0
    s_cmp_gt_i32 s53, 4
    s_cbranch_scc1 L_cw129
    s_waitcnt vmcnt(4)
L_cw129:
    s_waitcnt vmcnt(6)
    s_barrier
    buffer_load_dwordx4 a[228:231], v8, s[20:23], s44 offen offset:512 nt
    v_mfma_f32_16x16x32_bf16 v[164:167], a[200:203], v[120:123], v[164:167]
    v_add_f32_dpp v12, v156, v158 row_ror:8 row_mask:0xf bank_mask:0xf
    v_add_f32_dpp v12, v157, v12 row_ror:4 row_mask:0xf bank_mask:0xf
    v_add_f32_dpp v206, v159, v12 row_ror:12 row_mask:0xf bank_mask:0x4
    v_add_f32_dpp v12, v160, v162 row_ror:8 row_mask:0xf bank_mask:0xf
    v_add_f32_dpp v12, v161, v12 row_ror:4 row_mask:0xf bank_mask:0xf
    v_add_f32_dpp v207, v163, v12 row_ror:12 row_mask:0xf bank_mask:0x4
    s_cmp_gt_i32 s53, 5
    s_cbranch_scc1 L_cw130
    s_waitcnt vmcnt(4)
L_cw130:
    s_waitcnt vmcnt(6)
    s_barrier
    buffer_load_dwordx4 a[232:235], v8, s[20:23], s44 offen offset:256 nt
    v_mfma_f32_16x16x32_bf16 v[168:171], a[204:207], v[120:123], v[168:171]
    s_cmp_gt_i32 s53, 6
    s_cbranch_scc1 L_cw131
    s_waitcnt vmcnt(4)
L_cw131:
    s_waitcnt vmcnt(6)
    s_barrier
    buffer_load_dwordx4 a[236:239], v8, s[20:23], s44 offen offset:768 nt
    v_mfma_f32_16x16x32_bf16 v[164:167], a[208:211], v[108:111], v[164:167]
    s_add_u32 s44, s44, 0x10000
    s_cmp_gt_i32 s53, 7
    s_cbranch_scc1 L_cw132
    s_waitcnt vmcnt(4)
L_cw132:
    s_waitcnt vmcnt(6)
    s_barrier
    buffer_load_dwordx4 a[240:243], v8, s[20:23], s44 offen nt
    v_mfma_f32_16x16x32_bf16 v[168:171], a[212:215], v[108:111], v[168:171]
    s_cmp_gt_i32 s53, 8
    s_cbranch_scc1 L_cw133
    s_waitcnt vmcnt(4)
L_cw133:
    s_waitcnt vmcnt(6)
    s_barrier
    buffer_load_dwordx4 a[244:247], v8, s[20:23], s44 offen offset:512 nt
    v_mfma_f32_16x16x32_bf16 v[164:167], a[216:219], v[124:127], v[164:167]
    s_cmp_gt_i32 s53, 9
    s_cbranch_scc1 L_cw134
    s_waitcnt vmcnt(4)
L_cw134:
    s_waitcnt vmcnt(6)
    s_barrier
    buffer_load_dwordx4 a[248:251], v8, s[20:23], s44 offen offset:256 nt
    v_mfma_f32_16x16x32_bf16 v[168:171], a[220:223], v[124:127], v[168:171]
    s_cmp_gt_i32 s53, 10
    s_cbranch_scc1 L_cw135
    s_waitcnt vmcnt(4)
L_cw135:
    s_waitcnt vmcnt(6)
    s_barrier
    buffer_load_dwordx4 a[252:255], v8, s[20:23], s44 offen offset:768 nt
    v_mfma_f32_16x16x32_bf16 v[164:167], a[224:227], v[112:115], v[164:167]
    s_lshr_b32 s44, s2, 2
    s_lshl_b32 s44, s44, 21
    s_and_b32 s41, s2, 3
    s_lshl_b32 s41, s41, 7
    s_add_u32 s44, s44, s41
    s_cmp_gt_i32 s53, 11
    s_cbranch_scc1 L_cw136
    s_waitcnt vmcnt(4)
L_cw136:
    s_waitcnt vmcnt(6)
    s_barrier
    buffer_load_dwordx4 a[128:131], v9, s[24:27], s44 offen nt
    v_mfma_f32_16x16x32_bf16 v[168:171], a[228:231], v[112:115], v[168:171]
    s_addk_i32 s44, 0x4000
    s_cmp_gt_i32 s53, 12
    s_cbranch_scc1 L_cw137
    s_waitcnt vmcnt(4)
L_cw137:
    s_waitcnt vmcnt(6)
    s_barrier
    buffer_load_dwordx4 a[132:135], v9, s[24:27], s44 offen nt
    v_mfma_f32_16x16x32_bf16 v[164:167], a[232:235], v[128:131], v[164:167]
    s_addk_i32 s44, 0x4000
    s_cmp_gt_i32 s53, 13
    s_cbranch_scc1 L_cw138
    s_waitcnt vmcnt(4)
L_cw138:
    s_waitcnt vmcnt(6)
    s_barrier
    buffer_load_dwordx4 a[136:139], v9, s[24:27], s44 offen nt
    v_mfma_f32_16x16x32_bf16 v[168:171], a[236:239], v[128:131], v[168:171]
    s_addk_i32 s44, 0x4000
    s_cmp_gt_i32 s53, 14
    s_cbranch_scc1 L_cw139
    s_waitcnt vmcnt(4)
L_cw139:
    s_waitcnt vmcnt(6)
    s_barrier
    buffer_load_dwordx4 a[140:143], v9, s[24:27], s44 offen nt
    v_mfma_f32_16x16x32_bf16 v[164:167], a[240:243], v[116:119], v[164:167]
    s_addk_i32 s44, 0x4000
    s_cmp_gt_i32 s53, 15
    s_cbranch_scc1 L_cw140
    s_waitcnt vmcnt(4)
L_cw140:
    s_waitcnt vmcnt(6)
    s_barrier
    buffer_load_dwordx4 a[144:147], v9, s[24:27], s44 offen nt
    v_mfma_f32_16x16x32_bf16 v[168:171], a[244:247], v[116:119], v[168:171]
    s_addk_i32 s44, 0x4000
    s_cmp_gt_i32 s53, 16
    s_cbranch_scc1 L_cw141
    s_waitcnt vmcnt(4)
L_cw141:
    s_waitcnt vmcnt(6)
    s_barrier
    buffer_load_dwordx4 a[0:3], v9, s[24:27], s44 offen nt
    v_mfma_f32_16x16x32_bf16 v[164:167], a[248:251], v[132:135], v[164:167]
    s_addk_i32 s44, 0x4000
    s_cmp_gt_i32 s53, 17
    s_cbranch_scc1 L_cw142
    s_waitcnt vmcnt(4)
L_cw142:
    s_waitcnt vmcnt(6)
    s_barrier
    buffer_load_dwordx4 a[4:7], v9, s[24:27], s44 offen nt
    v_mfma_f32_16x16x32_bf16 v[168:171], a[252:255], v[132:135], v[168:171]
    s_nop 0
    v_add_f32_dpp v12, v164, v167 row_ror:12 row_mask:0xf bank_mask:0xf
    v_add_f32_dpp v12, v165, v12 row_ror:8 row_mask:0xf bank_mask:0xf
    v_add_f32_dpp v206, v166, v12 row_ror:4 row_mask:0xf bank_mask:0x8
    s_nop 3
    v_add_f32_dpp v12, v168, v171 row_ror:12 row_mask:0xf bank_mask:0xf
    v_add_f32_dpp v12, v169, v12 row_ror:8 row_mask:0xf bank_mask:0xf
    v_add_f32_dpp v207, v170, v12 row_ror:4 row_mask:0xf bank_mask:0x8
    s_lshl2_add_u32 s41, s2, s42
    s_mul_i32 s41, s41, 768
    s_add_u32 s41, s41, 262144
    v_cvt_pk_bf16_f32 v156, v204, v205
    v_cvt_pk_bf16_f32 v157, v206, v207
    v_mov_b32 v158, v103
    s_cmp_lg_u32 s52, 0
    s_cbranch_scc1 L_far_sc
    buffer_store_dwordx3 v[156:158], v56, s[32:35], s41 offen
L_near_sc:
    s_addk_i32 s44, 0x4000
    s_cmp_gt_i32 s53, 18
    s_cbranch_scc1 L_cw143
    s_waitcnt vmcnt(5)
L_cw143:
    s_waitcnt vmcnt(7)
    s_barrier
    buffer_load_dwordx4 a[8:11], v9, s[24:27], s44 offen nt
    s_addk_i32 s44, 0x4000
    s_cmp_gt_i32 s53, 19
    s_cbranch_scc1 L_cw144
    s_waitcnt vmcnt(5)
L_cw144:
    s_waitcnt vmcnt(7)
    s_barrier
    buffer_load_dwordx4 a[12:15], v9, s[24:27], s44 offen nt
    s_addk_i32 s44, 0x4000
    s_cmp_gt_i32 s53, 20
    s_cbranch_scc1 L_cw145
    s_waitcnt vmcnt(5)
L_cw145:
    s_waitcnt vmcnt(7)
    s_barrier
    buffer_load_dwordx4 a[16:19], v9, s[24:27], s44 offen nt
    s_addk_i32 s44, 0x4000
    s_cmp_gt_i32 s53, 21
    s_cbranch_scc1 L_cw146
    s_waitcnt vmcnt(5)
L_cw146:
    s_waitcnt vmcnt(7)
    s_barrier
    buffer_load_dwordx4 a[20:23], v9, s[24:27], s44 offen nt
    v_writelane_b32 v6, 2.0, 32
    buffer_load_dword v100, v6, s[32:35], 0 offen offset:640
    buffer_store_dword v101, v7, s[32:35], s54 offen offset:640
    buffer_store_dword v101, v233, s[32:35], 0 offen offset:2304 sc1
    s_addk_i32 s44, 0x4000
    s_cmp_gt_i32 s53, 22
    s_cbranch_scc1 L_cw147
    s_waitcnt vmcnt(8)
L_cw147:
    s_waitcnt vmcnt(10)
    s_barrier
    buffer_load_dwordx4 a[24:27], v9, s[24:27], s44 offen nt
    buffer_load_dword v235, v234, s[32:35], 0 offen offset:2304 sc1
    s_addk_i32 s44, 0x4000
    s_cmp_gt_i32 s53, 23
    s_cbranch_scc1 L_cw148
    s_waitcnt vmcnt(8)
L_cw148:
    s_waitcnt vmcnt(11)
    s_barrier
    buffer_load_dwordx4 a[28:31], v9, s[24:27], s44 offen nt
    s_addk_i32 s44, 0x4000
    s_cmp_gt_i32 s53, 24
    s_cbranch_scc1 L_cw149
    s_waitcnt vmcnt(8)
L_cw149:
    s_waitcnt vmcnt(11)
    s_barrier
    buffer_load_dwordx4 a[32:35], v9, s[24:27], s44 offen nt
    s_addk_i32 s44, 0x4000
    s_cmp_gt_i32 s53, 25
    s_cbranch_scc1 L_cw150
    s_waitcnt vmcnt(8)
L_cw150:
    s_waitcnt vmcnt(10)
    s_barrier
    buffer_load_dwordx4 a[36:39], v9, s[24:27], s44 offen nt
    s_addk_i32 s44, 0x4000
    s_cmp_gt_i32 s53, 26
    s_cbranch_scc1 L_cw151
    s_waitcnt vmcnt(8)
L_cw151:
    s_waitcnt vmcnt(10)
    s_barrier
    buffer_load_dwordx4 a[40:43], v9, s[24:27], s44 offen nt
    s_addk_i32 s44, 0x4000
    s_cmp_gt_i32 s53, 27
    s_cbranch_scc1 L_cw152
    s_waitcnt vmcnt(5)
L_cw152:
    s_waitcnt vmcnt(10)
    s_barrier
    buffer_load_dwordx4 a[44:47], v9, s[24:27], s44 offen nt
    s_addk_i32 s44, 0x4000
    s_cmp_gt_i32 s53, 28
    s_cbranch_scc1 L_cw153
    s_waitcnt vmcnt(4)
L_cw153:
    s_waitcnt vmcnt(10)
    s_barrier
    buffer_load_dwordx4 a[48:51], v9, s[24:27], s44 offen nt
    s_addk_i32 s44, 0x4000
    s_cmp_gt_i32 s53, 29
    s_cbranch_scc1 L_cw154
    s_waitcnt vmcnt(4)
L_cw154:
    s_waitcnt vmcnt(7)
    s_barrier
    buffer_load_dwordx4 a[52:55], v9, s[24:27], s44 offen nt
    s_and_b32 s53, s2, 3
    s_cmp_eq_u32 s53, 3
    s_cselect_b32 s53, 14, 0
    s_add_i32 s51, s51, s53
    v_cmp_eq_u32 s[58:59], v101, v100
    s_bcnt1_i32_b32 s53, s58
    s_mul_i32 s53, s53, 666
    s_sub_i32 s53, s53, 11322
    s_lshl_b32 s58, s51, 8
    s_add_i32 s58, s58, s68
    s_mul_i32 s58, s58, 26
    s_ashr_i32 s58, s58, 5
    s_add_i32 s53, s53, s58
    s_ashr_i32 s53, s53, 8
    s_addk_i32 s44, 0x4000
    s_cmp_gt_i32 s53, 0
    s_cbranch_scc1 L_cw155
    s_waitcnt vmcnt(4)
L_cw155:
    s_waitcnt vmcnt(6)
    s_barrier
    buffer_load_dwordx4 a[56:59], v9, s[24:27], s44 offen nt
    v_cmp_eq_u32 s[58:59], v101, v235
    s_bcnt1_i32_b32 s58, s58
    s_nop 0
    v_add_u32 v235, s58, v101
    buffer_store_dword v235, v233, s[32:35], 0 offen offset:256
    s_and_b32 s3, s2, 0xfc
    s_lshl2_add_u32 s3, s3, s42
    s_xor_b32 s40, s3, 16
    s_mul_i32 s3, s3, 768
    s_mul_i32 s40, s40, 768
    s_add_u32 s60, s3, 262144
    s_add_u32 s64, s40, 262144
    s_add_u32 s61, s60, 3072
    s_add_u32 s62, s61, 3072
    s_add_u32 s63, s62, 3072
    s_add_u32 s65, s64, 3072
    s_add_u32 s66, s65, 3072
    s_add_u32 s67, s66, 3072
    s_cmp_lg_u32 s52, 0
    s_cbranch_scc1 L_far_sc0
    buffer_load_dwordx3 v[20:22], v56, s[32:35], s60 offen
L_near_sc0:
    s_addk_i32 s44, 0x4000
    s_cmp_gt_i32 s53, 1
    s_cbranch_scc1 L_cw156
    s_waitcnt vmcnt(6)
L_cw156:
    s_waitcnt vmcnt(8)
    s_barrier
    buffer_load_dwordx4 a[60:63], v9, s[24:27], s44 offen nt
    s_cmp_lg_u32 s52, 0
    s_cbranch_scc1 L_far_sc1
    buffer_load_dwordx3 v[24:26], v56, s[32:35], s61 offen
L_near_sc1:
    s_cmp_lg_u32 s52, 0
    s_cbranch_scc1 L_far_sc2
    buffer_load_dwordx3 v[28:30], v56, s[32:35], s62 offen
L_near_sc2:
    s_addk_i32 s44, 0x4000
    s_cmp_gt_i32 s53, 2
    s_cbranch_scc1 L_cw157
    s_waitcnt vmcnt(8)
L_cw157:
    s_waitcnt vmcnt(10)
    s_barrier
    buffer_load_dwordx4 a[148:151], v9, s[24:27], s44 offen nt
    s_cmp_lg_u32 s52, 0
    s_cbranch_scc1 L_far_sc3
    buffer_load_dwordx3 v[32:34], v56, s[32:35], s63 offen
L_near_sc3:
    s_cmp_lg_u32 s52, 0
    s_cbranch_scc1 L_far_sc4
    buffer_load_dword v36, v56, s[32:35], s64 offen offset:8
L_near_sc4:
    s_addk_i32 s44, 0x4000
    s_cmp_gt_i32 s53, 3
    s_cbranch_scc1 L_cw158
    s_waitcnt vmcnt(10)
L_cw158:
    s_waitcnt vmcnt(12)
    s_barrier
    buffer_load_dwordx4 a[152:155], v9, s[24:27], s44 offen nt
    s_cmp_lg_u32 s52, 0
    s_cbranch_scc1 L_far_sc5
    buffer_load_dword v37, v56, s[32:35], s65 offen offset:8
L_near_sc5:
    s_cmp_lg_u32 s52, 0
    s_cbranch_scc1 L_far_sc6
    buffer_load_dword v38, v56, s[32:35], s66 offen offset:8
L_near_sc6:
    s_addk_i32 s44, 0x4000
    s_cmp_gt_i32 s53, 4
    s_cbranch_scc1 L_cw159
    s_waitcnt vmcnt(12)
L_cw159:
    s_waitcnt vmcnt(14)
    s_barrier
    buffer_load_dwordx4 a[156:159], v9, s[24:27], s44 offen nt
    s_cmp_lg_u32 s52, 0
    s_cbranch_scc1 L_far_sc7
    buffer_load_dword v39, v56, s[32:35], s67 offen offset:8
L_near_sc7:
    s_addk_i32 s44, 0x4000
    s_cmp_gt_i32 s53, 5
    s_cbranch_scc1 L_cw160
    s_waitcnt vmcnt(13)
L_cw160:
    s_waitcnt vmcnt(15)
    s_barrier
    buffer_load_dwordx4 a[160:163], v9, s[24:27], s44 offen nt
    s_addk_i32 s44, 0x4000
    s_cmp_gt_i32 s53, 6
    s_cbranch_scc1 L_cw161
    s_waitcnt vmcnt(11)
L_cw161:
    s_waitcnt vmcnt(15)
    s_barrier
    buffer_load_dwordx4 a[164:167], v9, s[24:27], s44 offen nt
    s_addk_i32 s44, 0x4000
    s_cmp_gt_i32 s53, 7
    s_cbranch_scc1 L_cw162
    s_waitcnt vmcnt(9)
L_cw162:
    s_waitcnt vmcnt(15)
    s_barrier
    buffer_load_dwordx4 a[168:171], v9, s[24:27], s44 offen nt
    s_addk_i32 s44, 0x4000
    s_cmp_gt_i32 s53, 8
    s_cbranch_scc1 L_cw163
    s_waitcnt vmcnt(7)
L_cw163:
    s_waitcnt vmcnt(13)
    s_barrier
    buffer_load_dwordx4 a[172:175], v9, s[24:27], s44 offen nt
    s_addk_i32 s44, 0x4000
    s_cmp_gt_i32 s53, 9
    s_cbranch_scc1 L_cw164
    s_waitcnt vmcnt(5)
L_cw164:
    s_waitcnt vmcnt(11)
    s_barrier
    buffer_load_dwordx4 a[176:179], v9, s[24:27], s44 offen nt
    s_addk_i32 s44, 0x4000
    s_cmp_gt_i32 s53, 10
    s_cbranch_scc1 L_cw165
    s_waitcnt vmcnt(4)
L_cw165:
    s_waitcnt vmcnt(9)
    s_barrier
    buffer_load_dwordx4 a[180:183], v9, s[24:27], s44 offen nt
    s_addk_i32 s44, 0x4000
    s_cmp_gt_i32 s53, 11
    s_cbranch_scc1 L_cw166
    s_waitcnt vmcnt(4)
L_cw166:
    s_waitcnt vmcnt(7)
    s_barrier
    buffer_load_dwordx4 a[184:187], v9, s[24:27], s44 offen nt
    s_addk_i32 s44, 0x4000
    s_cmp_gt_i32 s53, 12
    s_cbranch_scc1 L_cw167
    s_waitcnt vmcnt(4)
L_cw167:
    s_waitcnt vmcnt(6)
    s_barrier
    buffer_load_dwordx4 a[188:191], v9, s[24:27], s44 offen nt
    v_bitop3_b32 v2, v22, v26, v154 bitop3:0x7e
    v_bitop3_b32 v3, v30, v34, v154 bitop3:0x7e
    v_bitop3_b32 v4, v36, v37, v154 bitop3:0x7e
    v_or3_b32 v2, v2, v3, v4
    v_bitop3_b32 v3, v38, v39, v154 bitop3:0x7e
    v_or_b32 v2, v2, v3
    v_and_b32 v2, 0xffff, v2
    v_cmp_ne_u32 vcc, 0, v2
    s_cbranch_vccnz L_slow_sc
L_back_sc:
    v_lshlrev_b32 v104, 16, v20
    v_and_b32 v105, 0xffff0000, v20
    v_lshlrev_b32 v106, 16, v21
    v_and_b32 v107, 0xffff0000, v21
    v_lshlrev_b32 v108, 16, v24
    v_and_b32 v109, 0xffff0000, v24
    v_lshlrev_b32 v110, 16, v25
    v_and_b32 v111, 0xffff0000, v25
    v_lshlrev_b32 v112, 16, v28
    v_and_b32 v113, 0xffff0000, v28
    v_lshlrev_b32 v114, 16, v29
    v_and_b32 v115, 0xffff0000, v29
    v_lshlrev_b32 v116, 16, v32
    v_and_b32 v117, 0xffff0000, v32
    s_addk_i32 s44, 0x4000
    s_cmp_gt_i32 s53, 13
    s_cbranch_scc1 L_cw168
    s_waitcnt vmcnt(4)
L_cw168:
    s_waitcnt vmcnt(6)
    s_barrier
    buffer_load_dwordx4 a[192:195], v9, s[24:27], s44 offen nt
    v_lshlrev_b32 v118, 16, v33
    v_and_b32 v119, 0xffff0000, v33
    v_max3_f32 v136, v104, v105, v106
    v_max3_f32 v136, v136, v107, v108
    v_max3_f32 v136, v136, v109, v110
    v_max3_f32 v136, v136, v111, v112
    v_max3_f32 v136, v136, v113, v114
    v_max3_f32 v136, v136, v115, v116
    v_max3_f32 v136, v136, v117, v118
    v_max_f32 v136, v136, v119
    s_nop 1
    v_max_f32_dpp v136, v136, v136 quad_perm:[1,0,3,2] row_mask:0xf bank_mask:0xf
    s_nop 1
    v_max_f32_dpp v136, v136, v136 quad_perm:[2,3,0,1] row_mask:0xf bank_mask:0xf
    s_nop 1
    v_max_f32_dpp v136, v136, v136 row_ror:4 row_mask:0xf bank_mask:0xf
    s_nop 1
    v_max_f32_dpp v136, v136, v136 row_ror:8 row_mask:0xf bank_mask:0xf
    v_mov_b32 v2, v136
    s_nop 1
    v_permlane16_swap_b32 v136, v2
    v_max_f32 v136, v136, v2
    v_mov_b32 v2, v136
    s_nop 1
    v_permlane32_swap_b32 v136, v2
    s_addk_i32 s44, 0x4000
    s_cmp_gt_i32 s53, 14
    s_cbranch_scc1 L_cw169
    s_waitcnt vmcnt(4)
L_cw169:
    s_waitcnt vmcnt(6)
    s_barrier
    buffer_load_dwordx4 a[196:199], v9, s[24:27], s44 offen nt
    v_max_f32 v136, v136, v2
    v_mul_f32 v136, s48, v136
    v_fma_f32 v104, v104, s48, -v136
    v_exp_f32 v104, v104
    v_fma_f32 v105, v105, s48, -v136
    v_exp_f32 v105, v105
    v_fma_f32 v106, v106, s48, -v136
    v_exp_f32 v106, v106
    v_fma_f32 v107, v107, s48, -v136
    v_exp_f32 v107, v107
    v_fma_f32 v108, v108, s48, -v136
    v_exp_f32 v108, v108
    v_fma_f32 v109, v109, s48, -v136
    v_exp_f32 v109, v109
    v_fma_f32 v110, v110, s48, -v136
    s_addk_i32 s44, 0x4000
    s_cmp_gt_i32 s53, 15
    s_cbranch_scc1 L_cw170
    s_waitcnt vmcnt(4)
L_cw170:
    s_waitcnt vmcnt(6)
    s_barrier
    buffer_load_dwordx4 a[200:203], v9, s[24:27], s44 offen nt
    v_exp_f32 v110, v110
    v_fma_f32 v111, v111, s48, -v136
    v_exp_f32 v111, v111
    v_fma_f32 v112, v112, s48, -v136
    v_exp_f32 v112, v112
    v_fma_f32 v113, v113, s48, -v136
    v_exp_f32 v113, v113
    v_fma_f32 v114, v114, s48, -v136
    v_exp_f32 v114, v114
    v_fma_f32 v115, v115, s48, -v136
    v_exp_f32 v115, v115
    v_fma_f32 v116, v116, s48, -v136
    v_exp_f32 v116, v116
    v_fma_f32 v117, v117, s48, -v136
    s_addk_i32 s44, 0x4000
    s_cmp_gt_i32 s53, 16
    s_cbranch_scc1 L_cw171
    s_waitcnt vmcnt(4)
L_cw171:
    s_waitcnt vmcnt(6)
    s_barrier
    buffer_load_dwordx4 a[204:207], v9, s[24:27], s44 offen nt
    v_exp_f32 v117, v117
    v_fma_f32 v118, v118, s48, -v136
    v_exp_f32 v118, v118
    v_fma_f32 v119, v119, s48, -v136
    v_exp_f32 v119, v119
    v_cvt_pk_bf16_f32 v208, v104, v105
    v_cvt_pk_bf16_f32 v209, v106, v107
    v_cvt_pk_bf16_f32 v210, v108, v109
    v_cvt_pk_bf16_f32 v211, v110, v111
    v_cvt_pk_bf16_f32 v212, v112, v113
    v_cvt_pk_bf16_f32 v213, v114, v115
    v_cvt_pk_bf16_f32 v214, v116, v117
    v_cvt_pk_bf16_f32 v215, v118, v119
    v_add_f32 v104, v104, v112
    v_add_f32 v105, v105, v113
    v_add_f32 v106, v106, v114
    v_add_f32 v107, v107, v115
    v_add_f32 v108, v108, v116
    v_add_f32 v109, v109, v117
    v_add_f32 v110, v110, v118
    s_addk_i32 s44, 0x4000
    s_cmp_gt_i32 s53, 17
    s_cbranch_scc1 L_cw172
    s_waitcnt vmcnt(4)
L_cw172:
    s_waitcnt vmcnt(6)
    s_barrier
    buffer_load_dwordx4 a[208:211], v9, s[24:27], s44 offen nt
    s_and_b32 s58, s54, 0xffffe000
    s_add_u32 s58, s58, 768
    v_writelane_b32 v6, s58, 32
    buffer_load_dword v100, v6, s[32:35], 0 offen offset:768
    buffer_store_dword v101, v7, s[32:35], s54 offen offset:768
    v_mov_b32_dpp v216, v208 row_newbcast:0 row_mask:0xf bank_mask:0xf
    v_perm_b32 v92, v216, v216, v52
    v_perm_b32 v93, v216, v216, v53
    v_perm_b32 v94, v216, v216, v54
    v_perm_b32 v95, v216, v216, v55
    s_nop 1
    v_mfma_f32_16x16x32_bf16 v[160:163], a[128:131], v[92:95], 0
    v_mov_b32_dpp v217, v210 row_newbcast:0 row_mask:0xf bank_mask:0xf
    v_perm_b32 v96, v217, v217, v52
    v_perm_b32 v97, v217, v217, v53
    v_perm_b32 v98, v217, v217, v54
    v_perm_b32 v99, v217, v217, v55
    v_add_f32 v111, v111, v119
    s_addk_i32 s44, 0x4000
    s_cmp_gt_i32 s53, 18
    s_cbranch_scc1 L_cw173
    s_waitcnt vmcnt(6)
L_cw173:
    s_waitcnt vmcnt(8)
    s_barrier
    buffer_load_dwordx4 a[212:215], v9, s[24:27], s44 offen nt
    v_mfma_f32_16x16x32_bf16 v[160:163], a[132:135], v[96:99], v[160:163]
    v_mov_b32_dpp v216, v212 row_newbcast:0 row_mask:0xf bank_mask:0xf
    v_perm_b32 v92, v216, v216, v52
    v_perm_b32 v93, v216, v216, v53
    v_perm_b32 v94, v216, v216, v54
    v_perm_b32 v95, v216, v216, v55
    v_add_f32 v104, v104, v105
    v_add_f32 v106, v106, v107
    v_add_f32 v108, v108, v109
    v_add_f32 v110, v110, v111
    v_add_f32 v104, v104, v106
    v_add_f32 v108, v108, v110
    v_add_f32 v137, v104, v108
    s_nop 1
    v_add_f32_dpp v137, v137, v137 quad_perm:[1,0,3,2] row_mask:0xf bank_mask:0xf
    s_nop 1
    v_add_f32_dpp v137, v137, v137 quad_perm:[2,3,0,1] row_mask:0xf bank_mask:0xf
    s_nop 1
    v_add_f32_dpp v137, v137, v137 row_ror:4 row_mask:0xf bank_mask:0xf
    s_nop 1
    v_add_f32_dpp v137, v137, v137 row_ror:8 row_mask:0xf bank_mask:0xf
    s_addk_i32 s44, 0x4000
    s_cmp_gt_i32 s53, 19
    s_cbranch_scc1 L_cw174
    s_waitcnt vmcnt(6)
L_cw174:
    s_waitcnt vmcnt(8)
    s_barrier
    buffer_load_dwordx4 a[216:219], v9, s[24:27], s44 offen nt
    v_mfma_f32_16x16x32_bf16 v[160:163], a[136:139], v[92:95], v[160:163]
    v_mov_b32_dpp v217, v214 row_newbcast:0 row_mask:0xf bank_mask:0xf
    v_perm_b32 v96, v217, v217, v52
    v_perm_b32 v97, v217, v217, v53
    v_perm_b32 v98, v217, v217, v54
    v_perm_b32 v99, v217, v217, v55
    v_mov_b32 v2, v137
    s_nop 1
    v_permlane16_swap_b32 v137, v2
    v_add_f32 v137, v137, v2
    v_mov_b32 v2, v137
    s_nop 1
    v_permlane32_swap_b32 v137, v2
    v_add_f32 v137, v137, v2
    v_and_b32 v120, 0xffff0000, v22
    v_and_b32 v121, 0xffff0000, v26
    v_and_b32 v122, 0xffff0000, v30
    v_and_b32 v123, 0xffff0000, v34
    v_and_b32 v124, 0xffff0000, v36
    v_and_b32 v125, 0xffff0000, v37
    s_addk_i32 s44, 0x4000
    s_cmp_gt_i32 s53, 20
    s_cbranch_scc1 L_cw175
    s_waitcnt vmcnt(6)
L_cw175:
    s_waitcnt vmcnt(8)
    s_barrier
    buffer_load_dwordx4 a[220:223], v9, s[24:27], s44 offen nt
    v_mfma_f32_16x16x32_bf16 v[160:163], a[140:143], v[96:99], v[160:163]
    v_mov_b32_dpp v216, v208 row_newbcast:1 row_mask:0xf bank_mask:0xf
    v_perm_b32 v92, v216, v216, v52
    v_perm_b32 v93, v216, v216, v53
    v_perm_b32 v94, v216, v216, v54
    v_perm_b32 v95, v216, v216, v55
    v_and_b32 v126, 0xffff0000, v38
    v_and_b32 v127, 0xffff0000, v39
    v_max3_f32 v138, v120, v121, v122
    v_max3_f32 v138, v138, v123, v124
    v_max3_f32 v138, v138, v125, v126
    v_max_f32 v138, v138, v127
    s_nop 1
    v_max_f32_dpp v138, v138, v138 quad_perm:[1,0,3,2] row_mask:0xf bank_mask:0xf
    s_nop 1
    v_max_f32_dpp v138, v138, v138 row_ror:4 row_mask:0xf bank_mask:0xf
    s_nop 1
    v_max_f32_dpp v138, v138, v138 row_ror:8 row_mask:0xf bank_mask:0xf
    v_mov_b32 v2, v138
    s_nop 1
    v_permlane16_swap_b32 v138, v2
    s_addk_i32 s44, 0x4000
    s_cmp_gt_i32 s53, 21
    s_cbranch_scc1 L_cw176
    s_waitcnt vmcnt(6)
L_cw176:
    s_waitcnt vmcnt(8)
    s_barrier
    buffer_load_dwordx4 a[224:227], v9, s[24:27], s44 offen nt
    v_mfma_f32_16x16x32_bf16 v[160:163], a[144:147], v[92:95], v[160:163]
    v_mov_b32_dpp v217, v210 row_newbcast:1 row_mask:0xf bank_mask:0xf
    v_perm_b32 v96, v217, v217, v52
    v_perm_b32 v97, v217, v217, v53
    v_perm_b32 v98, v217, v217, v54
    v_perm_b32 v99, v217, v217, v55
    v_max_f32 v138, v138, v2
    v_mov_b32 v2, v138
    s_nop 1
    v_permlane32_swap_b32 v138, v2
    v_max_f32 v138, v138, v2
    v_mul_f32 v138, s48, v138
    v_fma_f32 v120, v120, s48, -v138
    v_exp_f32 v120, v120
    v_fma_f32 v121, v121, s48, -v138
    v_exp_f32 v121, v121
    v_fma_f32 v122, v122, s48, -v138
    s_addk_i32 s44, 0x4000
    s_cmp_gt_i32 s53, 22
    s_cbranch_scc1 L_cw177
    s_waitcnt vmcnt(6)
L_cw177:
    s_waitcnt vmcnt(8)
    s_barrier
    buffer_load_dwordx4 a[228:231], v9, s[24:27], s44 offen nt
    v_mfma_f32_16x16x32_bf16 v[160:163], a[0:3], v[96:99], v[160:163]
    v_mov_b32_dpp v216, v212 row_newbcast:1 row_mask:0xf bank_mask:0xf
    v_perm_b32 v92, v216, v216, v52
    v_perm_b32 v93, v216, v216, v53
    v_perm_b32 v94, v216, v216, v54
    v_perm_b32 v95, v216, v216, v55
    v_exp_f32 v122, v122
    v_fma_f32 v123, v123, s48, -v138
    v_exp_f32 v123, v123
    v_fma_f32 v124, v124, s48, -v138
    v_exp_f32 v124, v124
    v_fma_f32 v125, v125, s48, -v138
    v_exp_f32 v125, v125
    v_fma_f32 v126, v126, s48, -v138
    s_addk_i32 s44, 0x4000
    s_cmp_gt_i32 s53, 23
    s_cbranch_scc1 L_cw178
    s_waitcnt vmcnt(4)
L_cw178:
    s_waitcnt vmcnt(8)
    s_barrier
    buffer_load_dwordx4 a[232:235], v9, s[24:27], s44 offen nt
    v_mfma_f32_16x16x32_bf16 v[160:163], a[4:7], v[92:95], v[160:163]
    v_mov_b32_dpp v217, v214 row_newbcast:1 row_mask:0xf bank_mask:0xf
    v_perm_b32 v96, v217, v217, v52
    v_perm_b32 v97, v217, v217, v53
    v_perm_b32 v98, v217, v217, v54
    v_perm_b32 v99, v217, v217, v55
    v_exp_f32 v126, v126
    v_fma_f32 v127, v127, s48, -v138
    v_exp_f32 v127, v127
    v_mov_b32_dpp v2, v120 quad_perm:[1,0,3,2] row_mask:0xf bank_mask:0xf
    v_cvt_pk_bf16_f32 v140, v120, v2
    v_mov_b32_dpp v2, v121 quad_perm:[1,0,3,2] row_mask:0xf bank_mask:0xf
    v_cvt_pk_bf16_f32 v141, v121, v2
    v_mov_b32_dpp v2, v122 quad_perm:[1,0,3,2] row_mask:0xf bank_mask:0xf
    s_addk_i32 s44, 0x4000
    s_cmp_gt_i32 s53, 24
    s_cbranch_scc1 L_cw179
    s_waitcnt vmcnt(4)
L_cw179:
    s_waitcnt vmcnt(8)
    s_barrier
    buffer_load_dwordx4 a[236:239], v9, s[24:27], s44 offen nt
    v_mfma_f32_16x16x32_bf16 v[160:163], a[8:11], v[96:99], v[160:163]
    v_mov_b32_dpp v216, v208 row_newbcast:2 row_mask:0xf bank_mask:0xf
    v_perm_b32 v92, v216, v216, v52
    v_perm_b32 v93, v216, v216, v53
    v_perm_b32 v94, v216, v216, v54
    v_perm_b32 v95, v216, v216, v55
    v_cvt_pk_bf16_f32 v142, v122, v2
    v_mov_b32_dpp v2, v123 quad_perm:[1,0,3,2] row_mask:0xf bank_mask:0xf
    v_cvt_pk_bf16_f32 v143, v123, v2
    v_add_f32 v120, v120, v121
    v_add_f32 v122, v122, v123
    v_add_f32 v124, v124, v125
    v_add_f32 v126, v126, v127
    v_add_f32 v120, v120, v122
    v_add_f32 v124, v124, v126
    v_add_f32 v139, v120, v124
    s_nop 1
    v_add_f32_dpp v139, v139, v139 quad_perm:[1,0,3,2] row_mask:0xf bank_mask:0xf
    s_nop 1
    v_add_f32_dpp v139, v139, v139 row_ror:4 row_mask:0xf bank_mask:0xf
    s_addk_i32 s44, 0x4000
    s_cmp_gt_i32 s53, 25
    s_cbranch_scc1 L_cw180
    s_waitcnt vmcnt(4)
L_cw180:
    s_waitcnt vmcnt(6)
    s_barrier
    buffer_load_dwordx4 a[240:243], v9, s[24:27], s44 offen nt
    v_cmp_eq_u32 s[58:59], v101, v100
    s_bcnt1_i32_b32 s53, s58
    s_mul_i32 s53, s53, 563
    s_sub_i32 s53, s53, 9571
    v_readlane_b32 s58, v100, 32
    s_sub_u32 s58, s58, s43
    s_mul_i32 s68, s58, 1536
    s_sub_i32 s68, s68, 5376
    s_cmp_lt_u32 s58, 8
    s_cselect_b32 s68, s68, 0
    s_lshl_b32 s58, s51, 8
    s_add_i32 s58, s58, s68
    s_mul_i32 s58, s58, 22
    s_ashr_i32 s58, s58, 5
    s_add_i32 s53, s53, s58
    s_ashr_i32 s53, s53, 8
    v_mfma_f32_16x16x32_bf16 v[160:163], a[12:15], v[92:95], v[160:163]
    v_mov_b32_dpp v217, v210 row_newbcast:2 row_mask:0xf bank_mask:0xf
    v_perm_b32 v96, v217, v217, v52
    v_perm_b32 v97, v217, v217, v53
    v_perm_b32 v98, v217, v217, v54
    v_perm_b32 v99, v217, v217, v55
    v_add_f32_dpp v139, v139, v139 row_ror:8 row_mask:0xf bank_mask:0xf
    s_addk_i32 s44, 0x4000
    s_cmp_gt_i32 s53, 0
    s_cbranch_scc1 L_cw181
    s_waitcnt vmcnt(4)
L_cw181:
    s_waitcnt vmcnt(6)
    s_barrier
    buffer_load_dwordx4 a[244:247], v9, s[24:27], s44 offen nt
    v_mfma_f32_16x16x32_bf16 v[160:163], a[16:19], v[96:99], v[160:163]
    v_mov_b32_dpp v216, v212 row_newbcast:2 row_mask:0xf bank_mask:0xf
    v_perm_b32 v92, v216, v216, v52
    v_perm_b32 v93, v216, v216, v53
    v_perm_b32 v94, v216, v216, v54
    v_perm_b32 v95, v216, v216, v55
    v_mov_b32 v2, v139
    s_nop 1
    v_permlane16_swap_b32 v139, v2
    v_add_f32 v139, v139, v2
    v_mov_b32 v2, v139
    s_nop 1
    v_permlane32_swap_b32 v139, v2
    v_add_f32 v139, v139, v2
    v_bfe_u32 v2, v1, 1, 1
    v_lshlrev_b32 v2, 6, v2
    s_lshl_b32 s3, s42, 4
    v_add_u32 v2, s3, v2
    ds_write_b128 v2, v[136:139] offset:4096
    s_addk_i32 s44, 0x4000
    s_cmp_gt_i32 s53, 1
    s_cbranch_scc1 L_cw182
    s_waitcnt vmcnt(4)
L_cw182:
    s_waitcnt vmcnt(6)
    s_barrier
    buffer_load_dwordx4 a[248:251], v9, s[24:27], s44 offen nt
    v_mfma_f32_16x16x32_bf16 v[160:163], a[20:23], v[92:95], v[160:163]
    v_mov_b32_dpp v217, v214 row_newbcast:2 row_mask:0xf bank_mask:0xf
    v_perm_b32 v96, v217, v217, v52
    v_perm_b32 v97, v217, v217, v53
    v_perm_b32 v98, v217, v217, v54
    v_perm_b32 v99, v217, v217, v55
    v_mov_b32_dpp v2, v140 row_newbcast:0 row_mask:0xf bank_mask:0xf
    v_perm_b32 v220, v2, v2, v52
    v_perm_b32 v221, v2, v2, v53
    v_perm_b32 v222, v2, v2, v54
    v_perm_b32 v223, v2, v2, v55
    v_mov_b32_dpp v3, v140 row_newbcast:2 row_mask:0xf bank_mask:0xf
    v_perm_b32 v224, v3, v3, v52
    v_perm_b32 v225, v3, v3, v53
    v_perm_b32 v226, v3, v3, v54
    v_perm_b32 v227, v3, v3, v55
    v_mfma_f32_16x16x32_bf16 v[164:167], a[64:67], v[220:223], 0
    s_addk_i32 s44, 0x4000
    s_cmp_gt_i32 s53, 2
    s_cbranch_scc1 L_cw183
    s_waitcnt vmcnt(4)
L_cw183:
    s_waitcnt vmcnt(6)
    s_barrier
    buffer_load_dwordx4 a[252:255], v9, s[24:27], s44 offen nt
    v_mfma_f32_16x16x32_bf16 v[160:163], a[24:27], v[96:99], v[160:163]
    v_mov_b32_dpp v216, v208 row_newbcast:3 row_mask:0xf bank_mask:0xf
    v_perm_b32 v92, v216, v216, v52
    v_perm_b32 v93, v216, v216, v53
    v_perm_b32 v94, v216, v216, v54
    v_perm_b32 v95, v216, v216, v55
    v_mfma_f32_16x16x32_bf16 v[168:171], a[64:67], v[224:227], 0
    v_mov_b32_dpp v2, v140 row_newbcast:4 row_mask:0xf bank_mask:0xf
    v_perm_b32 v220, v2, v2, v52
    v_perm_b32 v221, v2, v2, v53
    v_perm_b32 v222, v2, v2, v54
    v_perm_b32 v223, v2, v2, v55
    v_mov_b32_dpp v3, v140 row_newbcast:6 row_mask:0xf bank_mask:0xf
    v_perm_b32 v224, v3, v3, v52
    v_perm_b32 v225, v3, v3, v53
    s_addk_i32 s44, 0x4000
    s_cmp_gt_i32 s53, 3
    s_cbranch_scc1 L_cw184
    s_waitcnt vmcnt(4)
L_cw184:
    s_waitcnt vmcnt(6)
    s_barrier
    buffer_load_dwordx4 a[128:131], v9, s[24:27], s44 offen nt
    v_mfma_f32_16x16x32_bf16 v[160:163], a[28:31], v[92:95], v[160:163]
    v_mov_b32_dpp v217, v210 row_newbcast:3 row_mask:0xf bank_mask:0xf
    v_perm_b32 v96, v217, v217, v52
    v_perm_b32 v97, v217, v217, v53
    v_perm_b32 v98, v217, v217, v54
    v_perm_b32 v99, v217, v217, v55
    v_perm_b32 v226, v3, v3, v54
    v_perm_b32 v227, v3, v3, v55
    v_mfma_f32_16x16x32_bf16 v[164:167], a[80:83], v[220:223], v[164:167]
    s_nop 0
    v_mfma_f32_16x16x32_bf16 v[168:171], a[80:83], v[224:227], v[168:171]
    v_mov_b32_dpp v2, v140 row_newbcast:8 row_mask:0xf bank_mask:0xf
    v_perm_b32 v220, v2, v2, v52
    v_perm_b32 v221, v2, v2, v53
    s_addk_i32 s44, 0x4000
    s_cmp_gt_i32 s53, 4
    s_cbranch_scc1 L_cw185
    s_waitcnt vmcnt(4)
L_cw185:
    s_waitcnt vmcnt(6)
    s_barrier
    buffer_load_dwordx4 a[132:135], v9, s[24:27], s44 offen nt
    v_mfma_f32_16x16x32_bf16 v[160:163], a[32:35], v[96:99], v[160:163]
    v_mov_b32_dpp v216, v212 row_newbcast:3 row_mask:0xf bank_mask:0xf
    v_perm_b32 v92, v216, v216, v52
    v_perm_b32 v93, v216, v216, v53
    v_perm_b32 v94, v216, v216, v54
    v_perm_b32 v95, v216, v216, v55
    v_perm_b32 v222, v2, v2, v54
    v_perm_b32 v223, v2, v2, v55
    v_mov_b32_dpp v3, v140 row_newbcast:10 row_mask:0xf bank_mask:0xf
    v_perm_b32 v224, v3, v3, v52
    v_perm_b32 v225, v3, v3, v53
    v_perm_b32 v226, v3, v3, v54
    v_perm_b32 v227, v3, v3, v55
    v_mfma_f32_16x16x32_bf16 v[164:167], a[96:99], v[220:223], v[164:167]
    s_nop 0
    v_mfma_f32_16x16x32_bf16 v[168:171], a[96:99], v[224:227], v[168:171]
    s_addk_i32 s44, 0x4000
    s_cmp_gt_i32 s53, 5
    s_cbranch_scc1 L_cw186
    s_waitcnt vmcnt(4)
L_cw186:
    s_waitcnt vmcnt(6)
    s_barrier
    buffer_load_dwordx4 a[136:139], v9, s[24:27], s44 offen nt
    v_mfma_f32_16x16x32_bf16 v[160:163], a[36:39], v[92:95], v[160:163]
    v_mov_b32_dpp v217, v214 row_newbcast:3 row_mask:0xf bank_mask:0xf
    v_perm_b32 v96, v217, v217, v52
    v_perm_b32 v97, v217, v217, v53
    v_perm_b32 v98, v217, v217, v54
    v_perm_b32 v99, v217, v217, v55
    v_mov_b32_dpp v2, v140 row_newbcast:12 row_mask:0xf bank_mask:0xf
    v_perm_b32 v220, v2, v2, v52
    v_perm_b32 v221, v2, v2, v53
    v_perm_b32 v222, v2, v2, v54
    v_perm_b32 v223, v2, v2, v55
    v_mov_b32_dpp v3, v140 row_newbcast:14 row_mask:0xf bank_mask:0xf
    v_perm_b32 v224, v3, v3, v52
    v_perm_b32 v225, v3, v3, v53
    v_perm_b32 v226, v3, v3, v54
    v_perm_b32 v227, v3, v3, v55
    v_mfma_f32_16x16x32_bf16 v[164:167], a[112:115], v[220:223], v[164:167]
    s_addk_i32 s44, 0x4000
    s_cmp_gt_i32 s53, 6
    s_cbranch_scc1 L_cw187
    s_waitcnt vmcnt(4)
L_cw187:
    s_waitcnt vmcnt(6)
    s_barrier
    buffer_load_dwordx4 a[140:143], v9, s[24:27], s44 offen nt
    v_mfma_f32_16x16x32_bf16 v[160:163], a[40:43], v[96:99], v[160:163]
    v_mov_b32_dpp v216, v208 row_newbcast:4 row_mask:0xf bank_mask:0xf
    v_perm_b32 v92, v216, v216, v52
    v_perm_b32 v93, v216, v216, v53
    v_perm_b32 v94, v216, v216, v54
    v_perm_b32 v95, v216, v216, v55
    v_mfma_f32_16x16x32_bf16 v[168:171], a[112:115], v[224:227], v[168:171]
    v_mov_b32_dpp v2, v141 row_newbcast:0 row_mask:0xf bank_mask:0xf
    v_perm_b32 v220, v2, v2, v52
    v_perm_b32 v221, v2, v2, v53
    v_perm_b32 v222, v2, v2, v54
    v_perm_b32 v223, v2, v2, v55
    v_mov_b32_dpp v3, v141 row_newbcast:2 row_mask:0xf bank_mask:0xf
    v_perm_b32 v224, v3, v3, v52
    v_perm_b32 v225, v3, v3, v53
    s_addk_i32 s44, 0x4000
    s_cmp_gt_i32 s53, 7
    s_cbranch_scc1 L_cw188
    s_waitcnt vmcnt(4)
L_cw188:
    s_waitcnt vmcnt(6)
    s_barrier
    buffer_load_dwordx4 a[144:147], v9, s[24:27], s44 offen nt
    v_mfma_f32_16x16x32_bf16 v[160:163], a[44:47], v[92:95], v[160:163]
    v_mov_b32_dpp v217, v210 row_newbcast:4 row_mask:0xf bank_mask:0xf
    v_perm_b32 v96, v217, v217, v52
    v_perm_b32 v97, v217, v217, v53
    v_perm_b32 v98, v217, v217, v54
    v_perm_b32 v99, v217, v217, v55
    v_perm_b32 v226, v3, v3, v54
    v_perm_b32 v227, v3, v3, v55
    v_mfma_f32_16x16x32_bf16 v[164:167], a[68:71], v[220:223], v[164:167]
    s_nop 0
    v_mfma_f32_16x16x32_bf16 v[168:171], a[68:71], v[224:227], v[168:171]
    v_mov_b32_dpp v2, v141 row_newbcast:4 row_mask:0xf bank_mask:0xf
    v_perm_b32 v220, v2, v2, v52
    v_perm_b32 v221, v2, v2, v53
    s_addk_i32 s44, 0x4000
    s_cmp_gt_i32 s53, 8
    s_cbranch_scc1 L_cw189
    s_waitcnt vmcnt(4)
L_cw189:
    s_waitcnt vmcnt(6)
    s_barrier
    buffer_load_dwordx4 a[0:3], v9, s[24:27], s44 offen nt
    v_mfma_f32_16x16x32_bf16 v[160:163], a[48:51], v[96:99], v[160:163]
    v_mov_b32_dpp v216, v212 row_newbcast:4 row_mask:0xf bank_mask:0xf
    v_perm_b32 v92, v216, v216, v52
    v_perm_b32 v93, v216, v216, v53
    v_perm_b32 v94, v216, v216, v54
    v_perm_b32 v95, v216, v216, v55
    v_perm_b32 v222, v2, v2, v54
    v_perm_b32 v223, v2, v2, v55
    v_mov_b32_dpp v3, v141 row_newbcast:6 row_mask:0xf bank_mask:0xf
    v_perm_b32 v224, v3, v3, v52
    v_perm_b32 v225, v3, v3, v53
    v_perm_b32 v226, v3, v3, v54
    v_perm_b32 v227, v3, v3, v55
    v_mfma_f32_16x16x32_bf16 v[164:167], a[84:87], v[220:223], v[164:167]
    s_nop 0
    v_mfma_f32_16x16x32_bf16 v[168:171], a[84:87], v[224:227], v[168:171]
    s_addk_i32 s44, 0x4000
    s_cmp_gt_i32 s53, 9
    s_cbranch_scc1 L_cw190
    s_waitcnt vmcnt(4)
L_cw190:
    s_waitcnt vmcnt(6)
    s_barrier
    buffer_load_dwordx4 a[4:7], v9, s[24:27], s44 offen nt
    v_mfma_f32_16x16x32_bf16 v[160:163], a[52:55], v[92:95], v[160:163]
    v_mov_b32_dpp v217, v214 row_newbcast:4 row_mask:0xf bank_mask:0xf
    v_perm_b32 v96, v217, v217, v52
    v_perm_b32 v97, v217, v217, v53
    v_perm_b32 v98, v217, v217, v54
    v_perm_b32 v99, v217, v217, v55
    v_mov_b32_dpp v2, v141 row_newbcast:8 row_mask:0xf bank_mask:0xf
    v_perm_b32 v220, v2, v2, v52
    v_perm_b32 v221, v2, v2, v53
    v_perm_b32 v222, v2, v2, v54
    v_perm_b32 v223, v2, v2, v55
    v_mov_b32_dpp v3, v141 row_newbcast:10 row_mask:0xf bank_mask:0xf
    v_perm_b32 v224, v3, v3, v52
    v_perm_b32 v225, v3, v3, v53
    v_perm_b32 v226, v3, v3, v54
    v_perm_b32 v227, v3, v3, v55
    v_mfma_f32_16x16x32_bf16 v[164:167], a[100:103], v[220:223], v[164:167]
    s_addk_i32 s44, 0x4000
    s_cmp_gt_i32 s53, 10
    s_cbranch_scc1 L_cw191
    s_waitcnt vmcnt(4)
L_cw191:
    s_waitcnt vmcnt(6)
    s_barrier
    buffer_load_dwordx4 a[8:11], v9, s[24:27], s44 offen nt
    v_mfma_f32_16x16x32_bf16 v[160:163], a[56:59], v[96:99], v[160:163]
    v_mov_b32_dpp v216, v208 row_newbcast:5 row_mask:0xf bank_mask:0xf
    v_perm_b32 v92, v216, v216, v52
    v_perm_b32 v93, v216, v216, v53
    v_perm_b32 v94, v216, v216, v54
    v_perm_b32 v95, v216, v216, v55
    v_mfma_f32_16x16x32_bf16 v[168:171], a[100:103], v[224:227], v[168:171]
    v_mov_b32_dpp v2, v141 row_newbcast:12 row_mask:0xf bank_mask:0xf
    v_perm_b32 v220, v2, v2, v52
    v_perm_b32 v221, v2, v2, v53
    v_perm_b32 v222, v2, v2, v54
    v_perm_b32 v223, v2, v2, v55
    v_mov_b32_dpp v3, v141 row_newbcast:14 row_mask:0xf bank_mask:0xf
    v_perm_b32 v224, v3, v3, v52
    v_perm_b32 v225, v3, v3, v53
    s_addk_i32 s44, 0x4000
    s_cmp_gt_i32 s53, 11
    s_cbranch_scc1 L_cw192
    s_waitcnt vmcnt(4)
L_cw192:
    s_waitcnt vmcnt(6)
    s_barrier
    buffer_load_dwordx4 a[12:15], v9, s[24:27], s44 offen nt
    v_mfma_f32_16x16x32_bf16 v[160:163], a[60:63], v[92:95], v[160:163]
    v_mov_b32_dpp v217, v210 row_newbcast:5 row_mask:0xf bank_mask:0xf
    v_perm_b32 v96, v217, v217, v52
    v_perm_b32 v97, v217, v217, v53
    v_perm_b32 v98, v217, v217, v54
    v_perm_b32 v99, v217, v217, v55
    v_perm_b32 v226, v3, v3, v54
    v_perm_b32 v227, v3, v3, v55
    v_mfma_f32_16x16x32_bf16 v[164:167], a[116:119], v[220:223], v[164:167]
    s_nop 0
    v_mfma_f32_16x16x32_bf16 v[168:171], a[116:119], v[224:227], v[168:171]
    v_mov_b32_dpp v2, v142 row_newbcast:0 row_mask:0xf bank_mask:0xf
    v_perm_b32 v220, v2, v2, v52
    v_perm_b32 v221, v2, v2, v53
    s_addk_i32 s44, 0x4000
    s_cmp_gt_i32 s53, 12
    s_cbranch_scc1 L_cw193
    s_waitcnt vmcnt(4)
L_cw193:
    s_waitcnt vmcnt(6)
    s_barrier
    buffer_load_dwordx4 a[16:19], v9, s[24:27], s44 offen nt
    v_mfma_f32_16x16x32_bf16 v[160:163], a[148:151], v[96:99], v[160:163]
    v_mov_b32_dpp v216, v212 row_newbcast:5 row_mask:0xf bank_mask:0xf
    v_perm_b32 v92, v216, v216, v52
    v_perm_b32 v93, v216, v216, v53
    v_perm_b32 v94, v216, v216, v54
    v_perm_b32 v95, v216, v216, v55
    v_perm_b32 v222, v2, v2, v54
    v_perm_b32 v223, v2, v2, v55
    v_mov_b32_dpp v3, v142 row_newbcast:2 row_mask:0xf bank_mask:0xf
    v_perm_b32 v224, v3, v3, v52
    v_perm_b32 v225, v3, v3, v53
    v_perm_b32 v226, v3, v3, v54
    v_perm_b32 v227, v3, v3, v55
    v_mfma_f32_16x16x32_bf16 v[164:167], a[72:75], v[220:223], v[164:167]
    s_nop 0
    v_mfma_f32_16x16x32_bf16 v[168:171], a[72:75], v[224:227], v[168:171]
    s_addk_i32 s44, 0x4000
    s_cmp_gt_i32 s53, 13
    s_cbranch_scc1 L_cw194
    s_waitcnt vmcnt(4)
L_cw194:
    s_waitcnt vmcnt(6)
    s_barrier
    buffer_load_dwordx4 a[20:23], v9, s[24:27], s44 offen nt
    v_writelane_b32 v6, 2.0, 32
    buffer_load_dword v100, v6, s[32:35], 0 offen offset:896
    buffer_store_dword v101, v7, s[32:35], s54 offen offset:896
    buffer_store_dword v101, v233, s[32:35], 0 offen offset:2432 sc1
    v_mfma_f32_16x16x32_bf16 v[160:163], a[152:155], v[92:95], v[160:163]
    v_mov_b32_dpp v217, v214 row_newbcast:5 row_mask:0xf bank_mask:0xf
    v_perm_b32 v96, v217, v217, v52
    v_perm_b32 v97, v217, v217, v53
    v_perm_b32 v98, v217, v217, v54
    v_perm_b32 v99, v217, v217, v55
    v_mov_b32_dpp v2, v142 row_newbcast:4 row_mask:0xf bank_mask:0xf
    s_addk_i32 s44, 0x4000
    s_cmp_gt_i32 s53, 14
    s_cbranch_scc1 L_cw195
    s_waitcnt vmcnt(7)
L_cw195:
    s_waitcnt vmcnt(9)
    s_barrier
    buffer_load_dwordx4 a[24:27], v9, s[24:27], s44 offen nt
    buffer_load_dword v235, v234, s[32:35], 0 offen offset:2432 sc1
    v_mfma_f32_16x16x32_bf16 v[160:163], a[156:159], v[96:99], v[160:163]
    v_mov_b32_dpp v216, v208 row_newbcast:6 row_mask:0xf bank_mask:0xf
    v_perm_b32 v92, v216, v216, v52
    v_perm_b32 v93, v216, v216, v53
    v_perm_b32 v94, v216, v216, v54
    v_perm_b32 v95, v216, v216, v55
    v_perm_b32 v220, v2, v2, v52
    s_addk_i32 s44, 0x4000
    s_cmp_gt_i32 s53, 15
    s_cbranch_scc1 L_cw196
    s_waitcnt vmcnt(8)
L_cw196:
    s_waitcnt vmcnt(10)
    s_barrier
    buffer_load_dwordx4 a[28:31], v9, s[24:27], s44 offen nt
    v_mfma_f32_16x16x32_bf16 v[160:163], a[160:163], v[92:95], v[160:163]
    v_mov_b32_dpp v217, v210 row_newbcast:6 row_mask:0xf bank_mask:0xf
    v_perm_b32 v96, v217, v217, v52
    v_perm_b32 v97, v217, v217, v53
    v_perm_b32 v98, v217, v217, v54
    v_perm_b32 v99, v217, v217, v55
    v_perm_b32 v221, v2, v2, v53
    v_perm_b32 v222, v2, v2, v54
    v_perm_b32 v223, v2, v2, v55
    v_mov_b32_dpp v3, v142 row_newbcast:6 row_mask:0xf bank_mask:0xf
    v_perm_b32 v224, v3, v3, v52
    v_perm_b32 v225, v3, v3, v53
    v_perm_b32 v226, v3, v3, v54
    v_perm_b32 v227, v3, v3, v55
    v_mfma_f32_16x16x32_bf16 v[164:167], a[88:91], v[220:223], v[164:167]
    s_nop 0
    v_mfma_f32_16x16x32_bf16 v[168:171], a[88:91], v[224:227], v[168:171]
    s_addk_i32 s44, 0x4000
    s_cmp_gt_i32 s53, 16
    s_cbranch_scc1 L_cw197
    s_waitcnt vmcnt(8)
L_cw197:
    s_waitcnt vmcnt(10)
    s_barrier
    buffer_load_dwordx4 a[32:35], v9, s[24:27], s44 offen nt
    v_mfma_f32_16x16x32_bf16 v[160:163], a[164:167], v[96:99], v[160:163]
    v_mov_b32_dpp v216, v212 row_newbcast:6 row_mask:0xf bank_mask:0xf
    v_perm_b32 v92, v216, v216, v52
    v_perm_b32 v93, v216, v216, v53
    v_perm_b32 v94, v216, v216, v54
    v_perm_b32 v95, v216, v216, v55
    v_mov_b32_dpp v2, v142 row_newbcast:8 row_mask:0xf bank_mask:0xf
    v_perm_b32 v220, v2, v2, v52
    v_perm_b32 v221, v2, v2, v53
    v_perm_b32 v222, v2, v2, v54
    v_perm_b32 v223, v2, v2, v55
    v_mov_b32_dpp v3, v142 row_newbcast:10 row_mask:0xf bank_mask:0xf
    v_perm_b32 v224, v3, v3, v52
    v_perm_b32 v225, v3, v3, v53
    v_perm_b32 v226, v3, v3, v54
    v_perm_b32 v227, v3, v3, v55
    v_mfma_f32_16x16x32_bf16 v[164:167], a[104:107], v[220:223], v[164:167]
    s_addk_i32 s44, 0x4000
    s_cmp_gt_i32 s53, 17
    s_cbranch_scc1 L_cw198
    s_waitcnt vmcnt(8)
L_cw198:
    s_waitcnt vmcnt(10)
    s_barrier
    buffer_load_dwordx4 a[36:39], v9, s[24:27], s44 offen nt
    v_mfma_f32_16x16x32_bf16 v[160:163], a[168:171], v[92:95], v[160:163]
    v_mov_b32_dpp v217, v214 row_newbcast:6 row_mask:0xf bank_mask:0xf
    v_perm_b32 v96, v217, v217, v52
    v_perm_b32 v97, v217, v217, v53
    v_perm_b32 v98, v217, v217, v54
    v_perm_b32 v99, v217, v217, v55
    v_mfma_f32_16x16x32_bf16 v[168:171], a[104:107], v[224:227], v[168:171]
    v_mov_b32_dpp v2, v142 row_newbcast:12 row_mask:0xf bank_mask:0xf
    v_perm_b32 v220, v2, v2, v52
    v_perm_b32 v221, v2, v2, v53
    v_perm_b32 v222, v2, v2, v54
    v_perm_b32 v223, v2, v2, v55
    v_mov_b32_dpp v3, v142 row_newbcast:14 row_mask:0xf bank_mask:0xf
    v_perm_b32 v224, v3, v3, v52
    v_perm_b32 v225, v3, v3, v53
    s_addk_i32 s44, 0x4000
    s_cmp_gt_i32 s53, 18
    s_cbranch_scc1 L_cw199
    s_waitcnt vmcnt(8)
L_cw199:
    s_waitcnt vmcnt(10)
    s_barrier
    buffer_load_dwordx4 a[40:43], v9, s[24:27], s44 offen nt
    v_mfma_f32_16x16x32_bf16 v[160:163], a[172:175], v[96:99], v[160:163]
    v_mov_b32_dpp v216, v208 row_newbcast:7 row_mask:0xf bank_mask:0xf
    v_perm_b32 v92, v216, v216, v52
    v_perm_b32 v93, v216, v216, v53
    v_perm_b32 v94, v216, v216, v54
    v_perm_b32 v95, v216, v216, v55
    v_perm_b32 v226, v3, v3, v54
    v_perm_b32 v227, v3, v3, v55
    v_mfma_f32_16x16x32_bf16 v[164:167], a[120:123], v[220:223], v[164:167]
    s_nop 0
    v_mfma_f32_16x16x32_bf16 v[168:171], a[120:123], v[224:227], v[168:171]
    v_mov_b32_dpp v2, v143 row_newbcast:0 row_mask:0xf bank_mask:0xf
    v_perm_b32 v220, v2, v2, v52
    v_perm_b32 v221, v2, v2, v53
    s_addk_i32 s44, 0x4000
    s_cmp_gt_i32 s53, 19
    s_cbranch_scc1 L_cw200
    s_waitcnt vmcnt(5)
L_cw200:
    s_waitcnt vmcnt(10)
    s_barrier
    buffer_load_dwordx4 a[44:47], v9, s[24:27], s44 offen nt
    v_mfma_f32_16x16x32_bf16 v[160:163], a[176:179], v[92:95], v[160:163]
    v_mov_b32_dpp v217, v210 row_newbcast:7 row_mask:0xf bank_mask:0xf
    v_perm_b32 v96, v217, v217, v52
    v_perm_b32 v97, v217, v217, v53
    v_perm_b32 v98, v217, v217, v54
    v_perm_b32 v99, v217, v217, v55
    v_perm_b32 v222, v2, v2, v54
    v_perm_b32 v223, v2, v2, v55
    v_mov_b32_dpp v3, v143 row_newbcast:2 row_mask:0xf bank_mask:0xf
    v_perm_b32 v224, v3, v3, v52
    v_perm_b32 v225, v3, v3, v53
    v_perm_b32 v226, v3, v3, v54
    v_perm_b32 v227, v3, v3, v55
    v_mfma_f32_16x16x32_bf16 v[164:167], a[76:79], v[220:223], v[164:167]
    s_nop 0
    v_mfma_f32_16x16x32_bf16 v[168:171], a[76:79], v[224:227], v[168:171]
    s_addk_i32 s44, 0x4000
    s_cmp_gt_i32 s53, 20
    s_cbranch_scc1 L_cw201
    s_waitcnt vmcnt(4)
L_cw201:
    s_waitcnt vmcnt(10)
    s_barrier
    buffer_load_dwordx4 a[48:51], v9, s[24:27], s44 offen nt
    v_mfma_f32_16x16x32_bf16 v[160:163], a[180:183], v[96:99], v[160:163]
    v_mov_b32_dpp v216, v212 row_newbcast:7 row_mask:0xf bank_mask:0xf
    v_perm_b32 v92, v216, v216, v52
    v_perm_b32 v93, v216, v216, v53
    v_perm_b32 v94, v216, v216, v54
    v_perm_b32 v95, v216, v216, v55
    v_mov_b32_dpp v2, v143 row_newbcast:4 row_mask:0xf bank_mask:0xf
    v_perm_b32 v220, v2, v2, v52
    v_perm_b32 v221, v2, v2, v53
    v_perm_b32 v222, v2, v2, v54
    v_perm_b32 v223, v2, v2, v55
    v_mov_b32_dpp v3, v143 row_newbcast:6 row_mask:0xf bank_mask:0xf
    v_perm_b32 v224, v3, v3, v52
    v_perm_b32 v225, v3, v3, v53
    v_perm_b32 v226, v3, v3, v54
    v_perm_b32 v227, v3, v3, v55
    v_mfma_f32_16x16x32_bf16 v[164:167], a[92:95], v[220:223], v[164:167]
    s_addk_i32 s44, 0x4000
    s_cmp_gt_i32 s53, 21
    s_cbranch_scc1 L_cw202
    s_waitcnt vmcnt(4)
L_cw202:
    s_waitcnt vmcnt(7)
    s_barrier
    buffer_load_dwordx4 a[52:55], v9, s[24:27], s44 offen nt
    v_cmp_eq_u32 s[58:59], v101, v100
    s_bcnt1_i32_b32 s53, s58
    s_mul_i32 s53, s53, 461
    s_sub_i32 s53, s53, 7837
    s_lshl_b32 s58, s51, 8
    s_add_i32 s58, s58, s68
    s_mul_i32 s58, s58, 18
    s_ashr_i32 s58, s58, 5
    s_add_i32 s53, s53, s58
    s_ashr_i32 s53, s53, 8
    v_mfma_f32_16x16x32_bf16 v[160:163], a[184:187], v[92:95], v[160:163]
    v_mov_b32_dpp v217, v214 row_newbcast:7 row_mask:0xf bank_mask:0xf
    v_perm_b32 v96, v217, v217, v52
    v_perm_b32 v97, v217, v217, v53
    v_perm_b32 v98, v217, v217, v54
    v_perm_b32 v99, v217, v217, v55
    v_mfma_f32_16x16x32_bf16 v[168:171], a[92:95], v[224:227], v[168:171]
    s_addk_i32 s44, 0x4000
    s_cmp_gt_i32 s53, 0
    s_cbranch_scc1 L_cw203
    s_waitcnt vmcnt(4)
L_cw203:
    s_waitcnt vmcnt(6)
    s_barrier
    buffer_load_dwordx4 a[56:59], v9, s[24:27], s44 offen nt
    v_cmp_eq_u32 s[58:59], v101, v235
    s_bcnt1_i32_b32 s58, s58
    s_nop 0
    v_add_u32 v235, s58, v101
    buffer_store_dword v235, v233, s[32:35], 0 offen offset:384
    v_mfma_f32_16x16x32_bf16 v[160:163], a[188:191], v[96:99], v[160:163]
    v_mov_b32_dpp v216, v208 row_newbcast:8 row_mask:0xf bank_mask:0xf
    v_perm_b32 v92, v216, v216, v52
    v_perm_b32 v93, v216, v216, v53
    v_perm_b32 v94, v216, v216, v54
    v_perm_b32 v95, v216, v216, v55
    v_mov_b32_dpp v2, v143 row_newbcast:8 row_mask:0xf bank_mask:0xf
    v_perm_b32 v220, v2, v2, v52
    v_perm_b32 v221, v2, v2, v53
    v_perm_b32 v222, v2, v2, v54
    v_perm_b32 v223, v2, v2, v55
    v_mov_b32_dpp v3, v143 row_newbcast:10 row_mask:0xf bank_mask:0xf
    s_addk_i32 s44, 0x4000
    s_cmp_gt_i32 s53, 1
    s_cbranch_scc1 L_cw204
    s_waitcnt vmcnt(5)
L_cw204:
    s_waitcnt vmcnt(7)
    s_barrier
    buffer_load_dwordx4 a[60:63], v9, s[24:27], s44 offen nt
    v_mfma_f32_16x16x32_bf16 v[160:163], a[192:195], v[92:95], v[160:163]
    v_mov_b32_dpp v217, v210 row_newbcast:8 row_mask:0xf bank_mask:0xf
    v_perm_b32 v96, v217, v217, v52
    v_perm_b32 v97, v217, v217, v53
    v_perm_b32 v98, v217, v217, v54
    v_perm_b32 v99, v217, v217, v55
    v_perm_b32 v224, v3, v3, v52
    v_perm_b32 v225, v3, v3, v53
    v_perm_b32 v226, v3, v3, v54
    v_perm_b32 v227, v3, v3, v55
    v_mfma_f32_16x16x32_bf16 v[164:167], a[108:111], v[220:223], v[164:167]
    s_nop 0
    v_mfma_f32_16x16x32_bf16 v[168:171], a[108:111], v[224:227], v[168:171]
    v_mov_b32_dpp v2, v143 row_newbcast:12 row_mask:0xf bank_mask:0xf
    s_addk_i32 s44, 0x4000
    s_cmp_gt_i32 s53, 2
    s_cbranch_scc1 L_cw205
    s_waitcnt vmcnt(5)
L_cw205:
    s_waitcnt vmcnt(7)
    s_barrier
    buffer_load_dwordx4 a[148:151], v9, s[24:27], s44 offen nt
    v_mfma_f32_16x16x32_bf16 v[160:163], a[196:199], v[96:99], v[160:163]
    v_mov_b32_dpp v216, v212 row_newbcast:8 row_mask:0xf bank_mask:0xf
    v_perm_b32 v92, v216, v216, v52
    v_perm_b32 v93, v216, v216, v53
    v_perm_b32 v94, v216, v216, v54
    v_perm_b32 v95, v216, v216, v55
    v_perm_b32 v220, v2, v2, v52
    v_perm_b32 v221, v2, v2, v53
    v_perm_b32 v222, v2, v2, v54
    v_perm_b32 v223, v2, v2, v55
    v_mov_b32_dpp v3, v143 row_newbcast:14 row_mask:0xf bank_mask:0xf
    v_perm_b32 v224, v3, v3, v52
    v_perm_b32 v225, v3, v3, v53
    v_perm_b32 v226, v3, v3, v54
    v_perm_b32 v227, v3, v3, v55
    v_mfma_f32_16x16x32_bf16 v[164:167], a[124:127], v[220:223], v[164:167]
    s_addk_i32 s44, 0x4000
    s_cmp_gt_i32 s53, 3
    s_cbranch_scc1 L_cw206
    s_waitcnt vmcnt(5)
L_cw206:
    s_waitcnt vmcnt(7)
    s_barrier
    buffer_load_dwordx4 a[152:155], v9, s[24:27], s44 offen nt
    v_mfma_f32_16x16x32_bf16 v[160:163], a[200:203], v[92:95], v[160:163]
    v_mov_b32_dpp v217, v214 row_newbcast:8 row_mask:0xf bank_mask:0xf
    v_perm_b32 v96, v217, v217, v52
    v_perm_b32 v97, v217, v217, v53
    v_perm_b32 v98, v217, v217, v54
    v_perm_b32 v99, v217, v217, v55
    v_mfma_f32_16x16x32_bf16 v[168:171], a[124:127], v[224:227], v[168:171]
    v_lshrrev_b32 v218, 4, v0
    v_lshlrev_b32 v218, 7, v218
    v_and_b32 v3, 7, v1
    v_lshl_add_u32 v218, v3, 4, v218
    v_and_b32 v219, 32, v1
    v_lshl_add_u32 v219, v3, 2, v219
    v_bfe_u32 v3, v1, 3, 2
    v_add_lshl_u32 v219, v219, v3, 2
    s_min_u32 s3, s42, 2
    s_lshl_b32 s3, s3, 11
    s_addk_i32 s44, 0x4000
    s_cmp_gt_i32 s53, 4
    s_cbranch_scc1 L_cw207
    s_waitcnt vmcnt(5)
L_cw207:
    s_waitcnt vmcnt(7)
    s_barrier
    buffer_load_dwordx4 a[156:159], v9, s[24:27], s44 offen nt
    v_mfma_f32_16x16x32_bf16 v[160:163], a[204:207], v[96:99], v[160:163]
    v_mov_b32_dpp v216, v208 row_newbcast:9 row_mask:0xf bank_mask:0xf
    v_perm_b32 v92, v216, v216, v52
    v_perm_b32 v93, v216, v216, v53
    v_perm_b32 v94, v216, v216, v54
    v_perm_b32 v95, v216, v216, v55
    v_add_u32 v219, s3, v219
    v_mov_b32 v146, 0xff
    s_mov_b32 exec_lo, 0x00ff00ff
    s_mov_b32 exec_hi, 0xff00ff00
    ds_write_b128 v218, v[164:167] offset:6400
    ds_write_b128 v218, v[168:171] offset:8448
    s_mov_b64 exec, -1
    s_bfe_u32 s3, s2, 0x20003
    s_lshr_b32 s40, s2, 6
    s_lshl2_add_u32 s3, s3, s40
    s_addk_i32 s44, 0x4000
    s_cmp_gt_i32 s53, 5
    s_cbranch_scc1 L_cw208
    s_waitcnt vmcnt(5)
L_cw208:
    s_waitcnt vmcnt(7)
    s_barrier
    buffer_load_dwordx4 a[160:163], v9, s[24:27], s44 offen nt
    v_mfma_f32_16x16x32_bf16 v[160:163], a[208:211], v[92:95], v[160:163]
    v_mov_b32_dpp v217, v210 row_newbcast:9 row_mask:0xf bank_mask:0xf
    v_perm_b32 v96, v217, v217, v52
    v_perm_b32 v97, v217, v217, v53
    v_perm_b32 v98, v217, v217, v54
    v_perm_b32 v99, v217, v217, v55
    s_and_b32 s40, s2, 7
    s_lshl4_add_u32 s50, s40, s3
    v_lshlrev_b32 v2, 3, v0
    v_lshrrev_b32 v154, v2, s43
    s_lshr_b32 s65, s43, 8
    s_lshr_b32 s66, s43, 16
    s_lshr_b32 s67, s43, 24
    s_bfe_u32 s3, s2, 0x30003
    s_mul_i32 s61, s3, 24576
    s_add_u32 s61, s61, 1048576
    s_lshr_b32 s3, s2, 6
    s_lshl_b32 s3, s3, 11
    s_add_u32 s60, s61, s3
    s_and_b32 s3, s2, 4
    s_addk_i32 s44, 0x4000
    s_cmp_gt_i32 s53, 6
    s_cbranch_scc1 L_cw209
    s_waitcnt vmcnt(4)
L_cw209:
    s_waitcnt vmcnt(7)
    s_barrier
    buffer_load_dwordx4 a[164:167], v9, s[24:27], s44 offen nt
    v_mfma_f32_16x16x32_bf16 v[160:163], a[212:215], v[96:99], v[160:163]
    v_mov_b32_dpp v216, v212 row_newbcast:9 row_mask:0xf bank_mask:0xf
    v_perm_b32 v92, v216, v216, v52
    v_perm_b32 v93, v216, v216, v53
    v_perm_b32 v94, v216, v216, v54
    v_perm_b32 v95, v216, v216, v55
    s_lshl_b32 s3, s3, 3
    s_lshl2_add_u32 s3, s42, s3
    s_and_b32 s40, s2, 3
    s_add_u32 s3, s3, s40
    s_addk_i32 s3, 28
    s_and_b32 s40, s2, 7
    s_cmp_eq_u32 s42, 0
    s_cselect_b32 s3, s40, s3
    s_lshl_b32 s3, s3, 8
    s_add_u32 s60, s60, s3
    s_lshr_b32 s3, s50, 4
    s_mul_i32 s61, s3, 24576
    s_add_u32 s61, s61, 1048576
    s_bfe_u32 s3, s2, 0x10005
    s_addk_i32 s44, 0x4000
    s_cmp_gt_i32 s53, 7
    s_cbranch_scc1 L_cw210
    s_waitcnt vmcnt(4)
L_cw210:
    s_waitcnt vmcnt(7)
    s_barrier
    buffer_load_dwordx4 a[168:171], v9, s[24:27], s44 offen nt
    v_mfma_f32_16x16x32_bf16 v[160:163], a[216:219], v[92:95], v[160:163]
    v_mov_b32_dpp v217, v214 row_newbcast:9 row_mask:0xf bank_mask:0xf
    v_perm_b32 v96, v217, v217, v52
    v_perm_b32 v97, v217, v217, v53
    v_perm_b32 v98, v217, v217, v54
    v_perm_b32 v99, v217, v217, v55
    s_lshl_b32 s3, s3, 13
    s_add_u32 s61, s61, s3
    s_and_b32 s40, s50, 1
    s_lshl_b32 s40, s40, 10
    s_add_u32 s61, s61, s40
    v_bfe_u32 v2, v0, 1, 1
    v_mul_lo_u32 v153, v2, s3
    v_bfe_u32 v2, v0, 2, 2
    v_lshl_add_u32 v153, v2, 11, v153
    v_lshrrev_b32 v2, 4, v0
    v_lshl_add_u32 v153, v2, 6, v153
    v_and_b32 v2, 1, v0
    v_lshl_add_u32 v153, v2, 5, v153
    v_lshrrev_b32 v2, 3, v0
    s_addk_i32 s44, 0x4000
    s_cmp_gt_i32 s53, 8
    s_cbranch_scc1 L_cw211
    s_waitcnt vmcnt(4)
L_cw211:
    s_waitcnt vmcnt(6)
    s_barrier
    buffer_load_dwordx4 a[172:175], v9, s[24:27], s44 offen nt
    v_mfma_f32_16x16x32_bf16 v[160:163], a[220:223], v[96:99], v[160:163]
    v_mov_b32_dpp v216, v208 row_newbcast:10 row_mask:0xf bank_mask:0xf
    v_perm_b32 v92, v216, v216, v52
    v_perm_b32 v93, v216, v216, v53
    v_perm_b32 v94, v216, v216, v54
    v_perm_b32 v95, v216, v216, v55
    v_mul_u32_u24 v155, 7168, v2
    v_and_b32 v2, 7, v0
    v_lshl_add_u32 v155, v2, 4, v155
    s_and_b32 s40, s50, 15
    v_mov_b32 v3, s40
    v_cmp_gt_u32 vcc, 14, v3
    s_nop 1
    v_cndmask_b32 v155, v5, v155, vcc
    s_lshr_b32 s3, s50, 4
    s_and_b32 s45, s50, 1
    s_lshl1_add_u32 s45, s3, s45
    s_mul_i32 s45, s45, 229376
    s_and_b32 s3, s50, 14
    s_lshl_b32 s3, s3, 6
    s_add_u32 s45, s45, s3
    s_addk_i32 s44, 0x4000
    s_cmp_gt_i32 s53, 9
    s_cbranch_scc1 L_cw212
    s_waitcnt vmcnt(4)
L_cw212:
    s_waitcnt vmcnt(6)
    s_barrier
    buffer_load_dwordx4 a[176:179], v9, s[24:27], s44 offen nt
    s_and_b32 s58, s54, 0xffffe000
    s_add_u32 s58, s58, 640
    v_writelane_b32 v6, s58, 32
    buffer_load_dword v100, v6, s[32:35], 0 offen offset:1024
    buffer_store_dword v101, v7, s[32:35], s54 offen offset:1024
    v_mfma_f32_16x16x32_bf16 v[160:163], a[224:227], v[92:95], v[160:163]
    v_mov_b32_dpp v217, v210 row_newbcast:10 row_mask:0xf bank_mask:0xf
    v_perm_b32 v96, v217, v217, v52
    v_perm_b32 v97, v217, v217, v53
    v_perm_b32 v98, v217, v217, v54
    v_perm_b32 v99, v217, v217, v55
    s_addk_i32 s44, 0x4000
    s_cmp_gt_i32 s53, 10
    s_cbranch_scc1 L_cw213
    s_waitcnt vmcnt(6)
L_cw213:
    s_waitcnt vmcnt(8)
    s_barrier
    buffer_load_dwordx4 a[180:183], v9, s[24:27], s44 offen nt
    v_mfma_f32_16x16x32_bf16 v[160:163], a[228:231], v[96:99], v[160:163]
    v_mov_b32_dpp v216, v212 row_newbcast:10 row_mask:0xf bank_mask:0xf
    v_perm_b32 v92, v216, v216, v52
    v_perm_b32 v93, v216, v216, v53
    v_perm_b32 v94, v216, v216, v54
    v_perm_b32 v95, v216, v216, v55
    v_lshlrev_b32 v57, 4, v0
    v_and_b32 v58, 1, v0
    v_bfe_u32 v3, v0, 3, 3
    v_lshl_add_u32 v58, v58, 3, v3
    v_lshrrev_b32 v3, 6, v0
    v_lshl_add_u32 v58, v3, 4, v58
    v_bfe_u32 v3, v0, 1, 2
    v_lshl_add_u32 v58, v58, 2, v3
    v_lshlrev_b32 v58, 2, v58
    v_lshlrev_b32 v56, 3, v2
    v_bfe_u32 v2, v1, 4, 1
    v_lshl_add_u32 v56, v2, 2, v56
    v_lshrrev_b32 v2, 5, v1
    v_lshl_add_u32 v56, v2, 1, v56
    s_addk_i32 s44, 0x4000
    s_cmp_gt_i32 s53, 11
    s_cbranch_scc1 L_cw214
    s_waitcnt vmcnt(6)
L_cw214:
    s_waitcnt vmcnt(8)
    s_barrier
    buffer_load_dwordx4 a[184:187], v9, s[24:27], s44 offen nt
    v_mfma_f32_16x16x32_bf16 v[160:163], a[232:235], v[92:95], v[160:163]
    v_mov_b32_dpp v217, v214 row_newbcast:10 row_mask:0xf bank_mask:0xf
    v_perm_b32 v96, v217, v217, v52
    v_perm_b32 v97, v217, v217, v53
    v_perm_b32 v98, v217, v217, v54
    v_perm_b32 v99, v217, v217, v55
    v_mul_u32_u24 v152, 8064, v2
    v_add_u32 v152, v152, v59
    s_bfe_u32 s3, s2, 0x10005
    s_mul_i32 s3, s3, 14
    s_add_u32 s3, s3, s40
    s_lshl_b32 s64, s3, 6
    s_mul_i32 s62, s42, 1792
    s_add_u32 s64, s64, s62
    s_lshl2_add_u32 s3, s3, s42
    s_lshl_b32 s3, s3, 11
    s_add_u32 s63, s3, 1310720
    s_and_b32 s40, s50, 1
    s_mul_i32 s3, s40, 7168
    s_sub_u32 s62, s63, s3
    s_addk_i32 s44, 0x4000
    s_cmp_gt_i32 s53, 12
    s_cbranch_scc1 L_cw215
    s_waitcnt vmcnt(6)
L_cw215:
    s_waitcnt vmcnt(8)
    s_barrier
    buffer_load_dwordx4 a[188:191], v9, s[24:27], s44 offen nt
    v_mfma_f32_16x16x32_bf16 v[160:163], a[236:239], v[96:99], v[160:163]
    v_mov_b32_dpp v216, v208 row_newbcast:11 row_mask:0xf bank_mask:0xf
    v_perm_b32 v92, v216, v216, v52
    v_perm_b32 v93, v216, v216, v53
    v_perm_b32 v94, v216, v216, v54
    v_perm_b32 v95, v216, v216, v55
    s_lshr_b32 s3, s50, 4
    s_lshl_b32 s41, s3, 7
    s_add_u32 s62, s62, s41
    s_lshl_b32 s41, s3, 3
    s_lshl_b64 s[6:7], 0xff, s41
    s_lshl_b32 s41, s40, 7
    v_lshl_add_u32 v232, v56, 1, s41
    s_xor_b32 s41, s40, 1
    s_lshl_b32 s41, s41, 10
    v_lshlrev_b32 v230, 4, v1
    v_add_u32 v231, 1024, v230
    v_add_u32 v2, s41, v230
    v_cndmask_b32 v230, v230, v2, s[6:7]
    v_cndmask_b32 v231, v231, v2, s[6:7]
    s_addk_i32 s44, 0x4000
    s_cmp_gt_i32 s53, 13
    s_cbranch_scc1 L_cw216
    s_waitcnt vmcnt(6)
L_cw216:
    s_waitcnt vmcnt(8)
    s_barrier
    buffer_load_dwordx4 a[192:195], v9, s[24:27], s44 offen nt
    v_mfma_f32_16x16x32_bf16 v[160:163], a[240:243], v[92:95], v[160:163]
    v_mov_b32_dpp v217, v210 row_newbcast:11 row_mask:0xf bank_mask:0xf
    v_perm_b32 v96, v217, v217, v52
    v_perm_b32 v97, v217, v217, v53
    v_perm_b32 v98, v217, v217, v54
    v_perm_b32 v99, v217, v217, v55
    s_sub_u32 s4, 0, s40
    s_not_b32 s5, s4
    s_and_b32 s40, s50, 7
    s_cmp_eq_u32 s3, s40
    s_cselect_b64 s[4:5], s[4:5], -1
    v_mfma_f32_16x16x32_bf16 v[160:163], a[244:247], v[96:99], v[160:163]
    v_mov_b32_dpp v216, v212 row_newbcast:11 row_mask:0xf bank_mask:0xf
    v_perm_b32 v92, v216, v216, v52
    v_perm_b32 v93, v216, v216, v53
    v_perm_b32 v94, v216, v216, v54
    v_perm_b32 v95, v216, v216, v55
    s_addk_i32 s44, 0x4000
    s_cmp_gt_i32 s53, 14
    s_cbranch_scc1 L_cw217
    s_waitcnt vmcnt(6)
L_cw217:
    s_waitcnt vmcnt(8)
    s_barrier
    buffer_load_dwordx4 a[196:199], v9, s[24:27], s44 offen nt
    v_mfma_f32_16x16x32_bf16 v[160:163], a[248:251], v[92:95], v[160:163]
    v_mov_b32_dpp v217, v214 row_newbcast:11 row_mask:0xf bank_mask:0xf
    v_perm_b32 v96, v217, v217, v52
    v_perm_b32 v97, v217, v217, v53
    v_perm_b32 v98, v217, v217, v54
    v_perm_b32 v99, v217, v217, v55
    s_nop 1
    v_mfma_f32_16x16x32_bf16 v[160:163], a[252:255], v[96:99], v[160:163]
    v_mov_b32_dpp v216, v208 row_newbcast:12 row_mask:0xf bank_mask:0xf
    v_perm_b32 v92, v216, v216, v52
    v_perm_b32 v93, v216, v216, v53
    v_perm_b32 v94, v216, v216, v54
    v_perm_b32 v95, v216, v216, v55
    s_addk_i32 s44, 0x4000
    s_cmp_gt_i32 s53, 15
    s_cbranch_scc1 L_cw218
    s_waitcnt vmcnt(4)
L_cw218:
    s_waitcnt vmcnt(8)
    s_barrier
    buffer_load_dwordx4 a[200:203], v9, s[24:27], s44 offen nt
    v_mfma_f32_16x16x32_bf16 v[160:163], a[128:131], v[92:95], v[160:163]
    v_mov_b32_dpp v217, v210 row_newbcast:12 row_mask:0xf bank_mask:0xf
    v_perm_b32 v96, v217, v217, v52
    v_perm_b32 v97, v217, v217, v53
    v_perm_b32 v98, v217, v217, v54
    v_perm_b32 v99, v217, v217, v55
    s_nop 1
    v_mfma_f32_16x16x32_bf16 v[160:163], a[132:135], v[96:99], v[160:163]
    v_mov_b32_dpp v216, v212 row_newbcast:12 row_mask:0xf bank_mask:0xf
    v_perm_b32 v92, v216, v216, v52
    v_perm_b32 v93, v216, v216, v53
    v_perm_b32 v94, v216, v216, v54
    v_perm_b32 v95, v216, v216, v55
    s_addk_i32 s44, 0x4000
    s_cmp_gt_i32 s53, 16
    s_cbranch_scc1 L_cw219
    s_waitcnt vmcnt(4)
L_cw219:
    s_waitcnt vmcnt(8)
    s_barrier
    buffer_load_dwordx4 a[64:67], v9, s[24:27], s44 offen nt
    v_mfma_f32_16x16x32_bf16 v[160:163], a[136:139], v[92:95], v[160:163]
    v_mov_b32_dpp v217, v214 row_newbcast:12 row_mask:0xf bank_mask:0xf
    v_perm_b32 v96, v217, v217, v52
    v_perm_b32 v97, v217, v217, v53
    v_perm_b32 v98, v217, v217, v54
    v_perm_b32 v99, v217, v217, v55
    s_nop 1
    v_mfma_f32_16x16x32_bf16 v[160:163], a[140:143], v[96:99], v[160:163]
    v_mov_b32_dpp v216, v208 row_newbcast:13 row_mask:0xf bank_mask:0xf
    v_perm_b32 v92, v216, v216, v52
    v_perm_b32 v93, v216, v216, v53
    v_perm_b32 v94, v216, v216, v54
    v_perm_b32 v95, v216, v216, v55
    s_addk_i32 s44, 0x4000
    s_cmp_gt_i32 s53, 17
    s_cbranch_scc1 L_cw220
    s_waitcnt vmcnt(4)
L_cw220:
    s_waitcnt vmcnt(6)
    s_barrier
    buffer_load_dwordx4 a[80:83], v9, s[24:27], s44 offen nt
    v_cmp_eq_u32 s[58:59], v101, v100
    s_bcnt1_i32_b32 s53, s58
    s_mul_i32 s53, s53, 358
    s_sub_i32 s53, s53, 6086
    v_readlane_b32 s58, v100, 32
    s_sub_u32 s58, s58, s43
    s_mul_i32 s68, s58, 1536
    s_sub_i32 s68, s68, 5376
    s_cmp_lt_u32 s58, 8
    s_cselect_b32 s68, s68, 0
    s_lshl_b32 s58, s51, 8
    s_add_i32 s58, s58, s68
    s_mul_i32 s58, s58, 14
    s_ashr_i32 s58, s58, 5
    s_add_i32 s53, s53, s58
    s_ashr_i32 s53, s53, 8
    v_mfma_f32_16x16x32_bf16 v[160:163], a[144:147], v[92:95], v[160:163]
    v_mov_b32_dpp v217, v210 row_newbcast:13 row_mask:0xf bank_mask:0xf
    v_perm_b32 v96, v217, v217, v52
    v_perm_b32 v97, v217, v217, v53
    v_perm_b32 v98, v217, v217, v54
    v_perm_b32 v99, v217, v217, v55
    s_addk_i32 s44, 0x4000
    s_cmp_gt_i32 s53, 0
    s_cbranch_scc1 L_cw221
    s_waitcnt vmcnt(4)
L_cw221:
    s_waitcnt vmcnt(6)
    s_barrier
    buffer_load_dwordx4 a[96:99], v9, s[24:27], s44 offen nt
    v_mfma_f32_16x16x32_bf16 v[160:163], a[0:3], v[96:99], v[160:163]
    v_mov_b32_dpp v216, v212 row_newbcast:13 row_mask:0xf bank_mask:0xf
    v_perm_b32 v92, v216, v216, v52
    v_perm_b32 v93, v216, v216, v53
    v_perm_b32 v94, v216, v216, v54
    v_perm_b32 v95, v216, v216, v55
    s_nop 1
    v_mfma_f32_16x16x32_bf16 v[160:163], a[4:7], v[92:95], v[160:163]
    v_mov_b32_dpp v217, v214 row_newbcast:13 row_mask:0xf bank_mask:0xf
    v_perm_b32 v96, v217, v217, v52
    v_perm_b32 v97, v217, v217, v53
    v_perm_b32 v98, v217, v217, v54
    v_perm_b32 v99, v217, v217, v55
    s_addk_i32 s44, 0x4000
    s_cmp_gt_i32 s53, 1
    s_cbranch_scc1 L_cw222
    s_waitcnt vmcnt(4)
L_cw222:
    s_waitcnt vmcnt(6)
    s_barrier
    buffer_load_dwordx4 a[112:115], v9, s[24:27], s44 offen nt
    v_mfma_f32_16x16x32_bf16 v[160:163], a[8:11], v[96:99], v[160:163]
    v_mov_b32_dpp v216, v208 row_newbcast:14 row_mask:0xf bank_mask:0xf
    v_perm_b32 v92, v216, v216, v52
    v_perm_b32 v93, v216, v216, v53
    v_perm_b32 v94, v216, v216, v54
    v_perm_b32 v95, v216, v216, v55
    s_nop 1
    v_mfma_f32_16x16x32_bf16 v[160:163], a[12:15], v[92:95], v[160:163]
    v_mov_b32_dpp v217, v210 row_newbcast:14 row_mask:0xf bank_mask:0xf
    v_perm_b32 v96, v217, v217, v52
    v_perm_b32 v97, v217, v217, v53
    v_perm_b32 v98, v217, v217, v54
    v_perm_b32 v99, v217, v217, v55
    s_addk_i32 s44, 0x4000
    s_cmp_gt_i32 s53, 2
    s_cbranch_scc1 L_cw223
    s_waitcnt vmcnt(4)
L_cw223:
    s_waitcnt vmcnt(6)
    s_barrier
    buffer_load_dwordx4 a[68:71], v9, s[24:27], s44 offen nt
    v_mfma_f32_16x16x32_bf16 v[160:163], a[16:19], v[96:99], v[160:163]
    v_mov_b32_dpp v216, v212 row_newbcast:14 row_mask:0xf bank_mask:0xf
    v_perm_b32 v92, v216, v216, v52
    v_perm_b32 v93, v216, v216, v53
    v_perm_b32 v94, v216, v216, v54
    v_perm_b32 v95, v216, v216, v55
    s_nop 1
    v_mfma_f32_16x16x32_bf16 v[160:163], a[20:23], v[92:95], v[160:163]
    v_mov_b32_dpp v217, v214 row_newbcast:14 row_mask:0xf bank_mask:0xf
    v_perm_b32 v96, v217, v217, v52
    v_perm_b32 v97, v217, v217, v53
    v_perm_b32 v98, v217, v217, v54
    v_perm_b32 v99, v217, v217, v55
    s_addk_i32 s44, 0x4000
    s_cmp_gt_i32 s53, 3
    s_cbranch_scc1 L_cw224
    s_waitcnt vmcnt(4)
L_cw224:
    s_waitcnt vmcnt(6)
    s_barrier
    buffer_load_dwordx4 a[84:87], v9, s[24:27], s44 offen nt
    v_mfma_f32_16x16x32_bf16 v[160:163], a[24:27], v[96:99], v[160:163]
    v_mov_b32_dpp v216, v208 row_newbcast:15 row_mask:0xf bank_mask:0xf
    v_perm_b32 v92, v216, v216, v52
    v_perm_b32 v93, v216, v216, v53
    v_perm_b32 v94, v216, v216, v54
    v_perm_b32 v95, v216, v216, v55
    s_nop 1
    v_mfma_f32_16x16x32_bf16 v[160:163], a[28:31], v[92:95], v[160:163]
    v_mov_b32_dpp v217, v210 row_newbcast:15 row_mask:0xf bank_mask:0xf
    v_perm_b32 v96, v217, v217, v52
    v_perm_b32 v97, v217, v217, v53
    v_perm_b32 v98, v217, v217, v54
    v_perm_b32 v99, v217, v217, v55
    s_addk_i32 s44, 0x4000
    s_cmp_gt_i32 s53, 4
    s_cbranch_scc1 L_cw225
    s_waitcnt vmcnt(4)
L_cw225:
    s_waitcnt vmcnt(6)
    s_barrier
    buffer_load_dwordx4 a[100:103], v9, s[24:27], s44 offen nt
    v_mfma_f32_16x16x32_bf16 v[160:163], a[32:35], v[96:99], v[160:163]
    v_mov_b32_dpp v216, v212 row_newbcast:15 row_mask:0xf bank_mask:0xf
    v_perm_b32 v92, v216, v216, v52
    v_perm_b32 v93, v216, v216, v53
    v_perm_b32 v94, v216, v216, v54
    v_perm_b32 v95, v216, v216, v55
    s_nop 1
    v_mfma_f32_16x16x32_bf16 v[160:163], a[36:39], v[92:95], v[160:163]
    v_mov_b32_dpp v217, v214 row_newbcast:15 row_mask:0xf bank_mask:0xf
    v_perm_b32 v96, v217, v217, v52
    v_perm_b32 v97, v217, v217, v53
    v_perm_b32 v98, v217, v217, v54
    v_perm_b32 v99, v217, v217, v55
    s_addk_i32 s44, 0x4000
    s_cmp_gt_i32 s53, 5
    s_cbranch_scc1 L_cw226
    s_waitcnt vmcnt(4)
L_cw226:
    s_waitcnt vmcnt(6)
    s_barrier
    buffer_load_dwordx4 a[116:119], v9, s[24:27], s44 offen nt
    v_writelane_b32 v6, 2.0, 32
    buffer_load_dword v100, v6, s[32:35], 0 offen offset:1152
    buffer_store_dword v101, v7, s[32:35], s54 offen offset:1152
    v_mfma_f32_16x16x32_bf16 v[160:163], a[40:43], v[96:99], v[160:163]
    v_mov_b32_dpp v216, v209 row_newbcast:0 row_mask:0xf bank_mask:0xf
    v_perm_b32 v92, v216, v216, v52
    v_perm_b32 v93, v216, v216, v53
    v_perm_b32 v94, v216, v216, v54
    v_perm_b32 v95, v216, v216, v55
    s_addk_i32 s44, 0x4000
    s_cmp_gt_i32 s53, 6
    s_cbranch_scc1 L_cw227
    s_waitcnt vmcnt(6)
L_cw227:
    s_waitcnt vmcnt(8)
    s_barrier
    buffer_load_dwordx4 a[72:75], v9, s[24:27], s44 offen nt
    v_mfma_f32_16x16x32_bf16 v[160:163], a[44:47], v[92:95], v[160:163]
    v_mov_b32_dpp v217, v211 row_newbcast:0 row_mask:0xf bank_mask:0xf
    v_perm_b32 v96, v217, v217, v52
    v_perm_b32 v97, v217, v217, v53
    v_perm_b32 v98, v217, v217, v54
    v_perm_b32 v99, v217, v217, v55
    s_nop 1
    v_mfma_f32_16x16x32_bf16 v[160:163], a[48:51], v[96:99], v[160:163]
    v_mov_b32_dpp v216, v213 row_newbcast:0 row_mask:0xf bank_mask:0xf
    v_perm_b32 v92, v216, v216, v52
    v_perm_b32 v93, v216, v216, v53
    v_perm_b32 v94, v216, v216, v54
    v_perm_b32 v95, v216, v216, v55
    s_addk_i32 s44, 0x4000
    s_cmp_gt_i32 s53, 7
    s_cbranch_scc1 L_cw228
    s_waitcnt vmcnt(6)
L_cw228:
    s_waitcnt vmcnt(8)
    s_barrier
    buffer_load_dwordx4 a[88:91], v9, s[24:27], s44 offen nt
    v_mfma_f32_16x16x32_bf16 v[160:163], a[52:55], v[92:95], v[160:163]
    v_mov_b32_dpp v217, v215 row_newbcast:0 row_mask:0xf bank_mask:0xf
    v_perm_b32 v96, v217, v217, v52
    v_perm_b32 v97, v217, v217, v53
    v_perm_b32 v98, v217, v217, v54
    v_perm_b32 v99, v217, v217, v55
    s_nop 1
    v_mfma_f32_16x16x32_bf16 v[160:163], a[56:59], v[96:99], v[160:163]
    v_mov_b32_dpp v216, v209 row_newbcast:1 row_mask:0xf bank_mask:0xf
    v_perm_b32 v92, v216, v216, v52
    v_perm_b32 v93, v216, v216, v53
    v_perm_b32 v94, v216, v216, v54
    v_perm_b32 v95, v216, v216, v55
    s_addk_i32 s44, 0x4000
    s_cmp_gt_i32 s53, 8
    s_cbranch_scc1 L_cw229
    s_waitcnt vmcnt(6)
L_cw229:
    s_waitcnt vmcnt(8)
    s_barrier
    buffer_load_dwordx4 a[104:107], v9, s[24:27], s44 offen nt
    v_mfma_f32_16x16x32_bf16 v[160:163], a[60:63], v[92:95], v[160:163]
    v_mov_b32_dpp v217, v211 row_newbcast:1 row_mask:0xf bank_mask:0xf
    v_perm_b32 v96, v217, v217, v52
    v_perm_b32 v97, v217, v217, v53
    v_perm_b32 v98, v217, v217, v54
    v_perm_b32 v99, v217, v217, v55
    s_nop 1
    v_mfma_f32_16x16x32_bf16 v[160:163], a[148:151], v[96:99], v[160:163]
    v_mov_b32_dpp v216, v213 row_newbcast:1 row_mask:0xf bank_mask:0xf
    v_perm_b32 v92, v216, v216, v52
    v_perm_b32 v93, v216, v216, v53
    v_perm_b32 v94, v216, v216, v54
    v_perm_b32 v95, v216, v216, v55
    s_addk_i32 s44, 0x4000
    s_cmp_gt_i32 s53, 9
    s_cbranch_scc1 L_cw230
    s_waitcnt vmcnt(6)
L_cw230:
    s_waitcnt vmcnt(8)
    s_barrier
    buffer_load_dwordx4 a[120:123], v9, s[24:27], s44 offen nt
    v_mfma_f32_16x16x32_bf16 v[160:163], a[152:155], v[92:95], v[160:163]
    v_mov_b32_dpp v217, v215 row_newbcast:1 row_mask:0xf bank_mask:0xf
    v_perm_b32 v96, v217, v217, v52
    v_perm_b32 v97, v217, v217, v53
    v_perm_b32 v98, v217, v217, v54
    v_perm_b32 v99, v217, v217, v55
    s_nop 1
    v_mfma_f32_16x16x32_bf16 v[160:163], a[156:159], v[96:99], v[160:163]
    v_mov_b32_dpp v216, v209 row_newbcast:2 row_mask:0xf bank_mask:0xf
    v_perm_b32 v92, v216, v216, v52
    v_perm_b32 v93, v216, v216, v53
    v_perm_b32 v94, v216, v216, v54
    v_perm_b32 v95, v216, v216, v55
    s_addk_i32 s44, 0x4000
    s_cmp_gt_i32 s53, 10
    s_cbranch_scc1 L_cw231
    s_waitcnt vmcnt(6)
L_cw231:
    s_waitcnt vmcnt(8)
    s_barrier
    buffer_load_dwordx4 a[76:79], v9, s[24:27], s44 offen nt
    v_mfma_f32_16x16x32_bf16 v[160:163], a[160:163], v[92:95], v[160:163]
    v_mov_b32_dpp v217, v211 row_newbcast:2 row_mask:0xf bank_mask:0xf
    v_perm_b32 v96, v217, v217, v52
    v_perm_b32 v97, v217, v217, v53
    v_perm_b32 v98, v217, v217, v54
    v_perm_b32 v99, v217, v217, v55
    s_min_u32 s3, s42, 1
    s_lshr_b32 s40, s42, 1
    s_lshl3_add_u32 s3, s40, s3
    s_lshl_b32 s3, s3, 3
    v_mov_b32 v2, s3
    s_waitcnt lgkmcnt(0)
    s_addk_i32 s44, 0x4000
    s_cmp_gt_i32 s53, 11
    s_cbranch_scc1 L_cw232
    s_waitcnt vmcnt(4)
L_cw232:
    s_waitcnt vmcnt(8)
    s_barrier
    buffer_load_dwordx4 a[92:95], v9, s[24:27], s44 offen nt
    v_mfma_f32_16x16x32_bf16 v[160:163], a[164:167], v[96:99], v[160:163]
    v_mov_b32_dpp v216, v213 row_newbcast:2 row_mask:0xf bank_mask:0xf
    v_perm_b32 v92, v216, v216, v52
    v_perm_b32 v93, v216, v216, v53
    v_perm_b32 v94, v216, v216, v54
    v_perm_b32 v95, v216, v216, v55
    s_barrier
    ds_read_b64 v[28:29], v2 offset:4096
    ds_read_b64 v[30:31], v2 offset:4112
    s_addk_i32 s44, 0x4000
    s_cmp_gt_i32 s53, 12
    s_cbranch_scc1 L_cw233
    s_waitcnt vmcnt(4)
L_cw233:
    s_waitcnt vmcnt(8)
    s_barrier
    buffer_load_dwordx4 a[108:111], v9, s[24:27], s44 offen nt
    v_mfma_f32_16x16x32_bf16 v[160:163], a[168:171], v[92:95], v[160:163]
    v_mov_b32_dpp v217, v215 row_newbcast:2 row_mask:0xf bank_mask:0xf
    v_perm_b32 v96, v217, v217, v52
    v_perm_b32 v97, v217, v217, v53
    v_perm_b32 v98, v217, v217, v54
    v_perm_b32 v99, v217, v217, v55
    ds_read_b64 v[32:33], v2 offset:4128
    ds_read_b64 v[34:35], v2 offset:4144
    ds_read2st64_b32 v[20:21], v219 offset0:17 offset1:18
    ds_read2st64_b32 v[22:23], v219 offset0:19 offset1:20
    ds_read2st64_b32 v[24:25], v219 offset0:21 offset1:22
    s_addk_i32 s44, 0x4000
    s_cmp_gt_i32 s53, 13
    s_cbranch_scc1 L_cw234
    s_waitcnt vmcnt(4)
L_cw234:
    s_waitcnt vmcnt(6)
    s_barrier
    buffer_load_dwordx4 a[124:127], v9, s[24:27], s44 offen nt
    v_cmp_eq_u32 s[58:59], v101, v100
    s_bcnt1_i32_b32 s53, s58
    s_mul_i32 s53, s53, 307
    s_sub_i32 s53, s53, 5219
    s_lshl_b32 s58, s51, 8
    s_add_i32 s58, s58, s68
    s_mul_i32 s58, s58, 12
    s_ashr_i32 s58, s58, 5
    s_add_i32 s53, s53, s58
    s_ashr_i32 s53, s53, 8
    v_mfma_f32_16x16x32_bf16 v[160:163], a[172:175], v[96:99], v[160:163]
    v_mov_b32_dpp v216, v209 row_newbcast:3 row_mask:0xf bank_mask:0xf
    v_perm_b32 v92, v216, v216, v52
    v_perm_b32 v93, v216, v216, v53
    v_perm_b32 v94, v216, v216, v54
    v_perm_b32 v95, v216, v216, v55
    ds_read2st64_b32 v[26:27], v219 offset0:23 offset1:24
    s_addk_i32 s44, 0x4000
    s_cmp_gt_i32 s53, 0
    s_cbranch_scc1 L_cw235
    s_waitcnt vmcnt(4)
L_cw235:
    s_waitcnt vmcnt(6)
    s_barrier
    buffer_load_dwordx4 a[204:207], v9, s[24:27], s44 offen nt
    v_mfma_f32_16x16x32_bf16 v[160:163], a[176:179], v[92:95], v[160:163]
    v_mov_b32_dpp v217, v211 row_newbcast:3 row_mask:0xf bank_mask:0xf
    v_perm_b32 v96, v217, v217, v52
    v_perm_b32 v97, v217, v217, v53
    v_perm_b32 v98, v217, v217, v54
    v_perm_b32 v99, v217, v217, v55
    v_add_u32 v228, 64, v0
    v_and_b32 v228, 128, v228
    v_cmp_ne_u32 vcc, 0, v228
    s_nop 1
    v_cndmask_b32 v228, v5, v59, vcc
    s_waitcnt lgkmcnt(0)
    s_addk_i32 s44, 0x4000
    s_cmp_gt_i32 s53, 1
    s_cbranch_scc1 L_cw236
    s_waitcnt vmcnt(4)
L_cw236:
    s_waitcnt vmcnt(6)
    s_barrier
    buffer_load_dwordx4 a[208:211], v9, s[24:27], s44 offen nt
    v_mfma_f32_16x16x32_bf16 v[160:163], a[180:183], v[96:99], v[160:163]
    v_mov_b32_dpp v216, v213 row_newbcast:3 row_mask:0xf bank_mask:0xf
    v_perm_b32 v92, v216, v216, v52
    v_perm_b32 v93, v216, v216, v53
    v_perm_b32 v94, v216, v216, v54
    v_perm_b32 v95, v216, v216, v55
    v_max3_f32 v2, v28, v30, v32
    v_max_f32 v2, v2, v34
    v_sub_f32 v28, v28, v2
    v_exp_f32 v28, v28
    v_sub_f32 v30, v30, v2
    v_exp_f32 v30, v30
    v_sub_f32 v32, v32, v2
    v_exp_f32 v32, v32
    v_sub_f32 v34, v34, v2
    s_addk_i32 s44, 0x4000
    s_cmp_gt_i32 s53, 2
    s_cbranch_scc1 L_cw237
    s_waitcnt vmcnt(4)
L_cw237:
    s_waitcnt vmcnt(6)
    s_barrier
    buffer_load_dwordx4 a[212:215], v9, s[24:27], s44 offen nt
    v_mfma_f32_16x16x32_bf16 v[160:163], a[184:187], v[92:95], v[160:163]
    v_mov_b32_dpp v217, v215 row_newbcast:3 row_mask:0xf bank_mask:0xf
    v_perm_b32 v96, v217, v217, v52
    v_perm_b32 v97, v217, v217, v53
    v_perm_b32 v98, v217, v217, v54
    v_perm_b32 v99, v217, v217, v55
    v_exp_f32 v34, v34
    v_mul_f32 v3, v28, v29
    v_fmac_f32 v3, v30, v31
    v_fmac_f32 v3, v32, v33
    v_fmac_f32 v3, v34, v35
    v_rcp_f32 v3, v3
    v_add_f32 v20, v20, v21
    v_add_f32 v22, v22, v23
    v_add_f32 v24, v24, v25
    v_add_f32 v26, v26, v27
    v_mul_f32 v148, v28, v3
    s_addk_i32 s44, 0x4000
    s_cmp_gt_i32 s53, 3
    s_cbranch_scc1 L_cw238
    s_waitcnt vmcnt(4)
L_cw238:
    s_waitcnt vmcnt(6)
    s_barrier
    buffer_load_dwordx4 a[216:219], v9, s[24:27], s44 offen nt
    buffer_load_dword v100, v6, s[32:35], 0 offen offset:1280
    buffer_store_dword v101, v7, s[32:35], s54 offen offset:1280
    v_mfma_f32_16x16x32_bf16 v[160:163], a[188:191], v[96:99], v[160:163]
    v_mov_b32_dpp v216, v209 row_newbcast:4 row_mask:0xf bank_mask:0xf
    v_perm_b32 v92, v216, v216, v52
    v_perm_b32 v93, v216, v216, v53
    v_perm_b32 v94, v216, v216, v54
    v_perm_b32 v95, v216, v216, v55
    v_mul_f32 v149, v30, v3
    s_addk_i32 s44, 0x4000
    s_cmp_gt_i32 s53, 4
    s_cbranch_scc1 L_cw239
    s_waitcnt vmcnt(6)
L_cw239:
    s_waitcnt vmcnt(8)
    s_barrier
    buffer_load_dwordx4 a[220:223], v9, s[24:27], s44 offen nt
    v_mfma_f32_16x16x32_bf16 v[160:163], a[192:195], v[92:95], v[160:163]
    v_mov_b32_dpp v217, v211 row_newbcast:4 row_mask:0xf bank_mask:0xf
    v_perm_b32 v96, v217, v217, v52
    v_perm_b32 v97, v217, v217, v53
    v_perm_b32 v98, v217, v217, v54
    v_perm_b32 v99, v217, v217, v55
    v_mul_f32 v150, v32, v3
    v_mul_f32 v151, v34, v3
    v_mul_f32 v20, v20, v148
    v_fmac_f32 v20, v22, v149
    v_fmac_f32 v20, v24, v150
    v_fmac_f32 v20, v26, v151
    v_bfi_b32 v229, v146, v154, v20
    v_mfma_f32_16x16x32_bf16 v[160:163], a[196:199], v[96:99], v[160:163]
    v_mov_b32_dpp v216, v213 row_newbcast:4 row_mask:0xf bank_mask:0xf
    v_perm_b32 v92, v216, v216, v52
    v_perm_b32 v93, v216, v216, v53
    v_perm_b32 v94, v216, v216, v54
    v_perm_b32 v95, v216, v216, v55
    s_addk_i32 s44, 0x4000
    s_cmp_gt_i32 s53, 5
    s_cbranch_scc1 L_cw240
    s_waitcnt vmcnt(6)
L_cw240:
    s_waitcnt vmcnt(8)
    s_barrier
    buffer_load_dwordx4 a[224:227], v9, s[24:27], s44 offen nt
    v_mfma_f32_16x16x32_bf16 v[160:163], a[200:203], v[92:95], v[160:163]
    v_mov_b32_dpp v217, v215 row_newbcast:4 row_mask:0xf bank_mask:0xf
    v_perm_b32 v96, v217, v217, v52
    v_perm_b32 v97, v217, v217, v53
    v_perm_b32 v98, v217, v217, v54
    v_perm_b32 v99, v217, v217, v55
    s_nop 1
    v_mfma_f32_16x16x32_bf16 v[160:163], a[64:67], v[96:99], v[160:163]
    v_mov_b32_dpp v216, v209 row_newbcast:5 row_mask:0xf bank_mask:0xf
    v_perm_b32 v92, v216, v216, v52
    v_perm_b32 v93, v216, v216, v53
    v_perm_b32 v94, v216, v216, v54
    v_perm_b32 v95, v216, v216, v55
    s_addk_i32 s44, 0x4000
    s_cmp_gt_i32 s53, 6
    s_cbranch_scc1 L_cw241
    s_waitcnt vmcnt(6)
L_cw241:
    s_waitcnt vmcnt(8)
    s_barrier
    buffer_load_dwordx4 a[228:231], v9, s[24:27], s44 offen nt
    v_mfma_f32_16x16x32_bf16 v[160:163], a[80:83], v[92:95], v[160:163]
    v_mov_b32_dpp v217, v211 row_newbcast:5 row_mask:0xf bank_mask:0xf
    v_perm_b32 v96, v217, v217, v52
    v_perm_b32 v97, v217, v217, v53
    v_perm_b32 v98, v217, v217, v54
    v_perm_b32 v99, v217, v217, v55
    s_nop 1
    v_mfma_f32_16x16x32_bf16 v[160:163], a[96:99], v[96:99], v[160:163]
    v_mov_b32_dpp v216, v213 row_newbcast:5 row_mask:0xf bank_mask:0xf
    v_perm_b32 v92, v216, v216, v52
    v_perm_b32 v93, v216, v216, v53
    v_perm_b32 v94, v216, v216, v54
    v_perm_b32 v95, v216, v216, v55
    s_addk_i32 s44, 0x4000
    s_cmp_gt_i32 s53, 7
    s_cbranch_scc1 L_cw242
    s_waitcnt vmcnt(6)
L_cw242:
    s_waitcnt vmcnt(8)
    s_barrier
    buffer_load_dwordx4 a[232:235], v9, s[24:27], s44 offen nt
    v_mfma_f32_16x16x32_bf16 v[160:163], a[112:115], v[92:95], v[160:163]
    v_mov_b32_dpp v217, v215 row_newbcast:5 row_mask:0xf bank_mask:0xf
    v_perm_b32 v96, v217, v217, v52
    v_perm_b32 v97, v217, v217, v53
    v_perm_b32 v98, v217, v217, v54
    v_perm_b32 v99, v217, v217, v55
    s_nop 1
    v_mfma_f32_16x16x32_bf16 v[160:163], a[68:71], v[96:99], v[160:163]
    v_mov_b32_dpp v216, v209 row_newbcast:6 row_mask:0xf bank_mask:0xf
    v_perm_b32 v92, v216, v216, v52
    v_perm_b32 v93, v216, v216, v53
    v_perm_b32 v94, v216, v216, v54
    v_perm_b32 v95, v216, v216, v55
    s_addk_i32 s44, 0x4000
    s_cmp_gt_i32 s53, 8
    s_cbranch_scc1 L_cw243
    s_waitcnt vmcnt(6)
L_cw243:
    s_waitcnt vmcnt(8)
    s_barrier
    buffer_load_dwordx4 a[236:239], v9, s[24:27], s44 offen nt
    v_mfma_f32_16x16x32_bf16 v[160:163], a[84:87], v[92:95], v[160:163]
    v_mov_b32_dpp v217, v211 row_newbcast:6 row_mask:0xf bank_mask:0xf
    v_perm_b32 v96, v217, v217, v52
    v_perm_b32 v97, v217, v217, v53
    v_perm_b32 v98, v217, v217, v54
    v_perm_b32 v99, v217, v217, v55
    s_nop 1
    v_mfma_f32_16x16x32_bf16 v[160:163], a[100:103], v[96:99], v[160:163]
    v_mov_b32_dpp v216, v213 row_newbcast:6 row_mask:0xf bank_mask:0xf
    v_perm_b32 v92, v216, v216, v52
    v_perm_b32 v93, v216, v216, v53
    v_perm_b32 v94, v216, v216, v54
    v_perm_b32 v95, v216, v216, v55
    s_addk_i32 s44, 0x4000
    s_cmp_gt_i32 s53, 9
    s_cbranch_scc1 L_cw244
    s_waitcnt vmcnt(4)
L_cw244:
    s_waitcnt vmcnt(8)
    s_barrier
    buffer_load_dwordx4 a[240:243], v9, s[24:27], s44 offen nt
    v_mfma_f32_16x16x32_bf16 v[160:163], a[116:119], v[92:95], v[160:163]
    v_mov_b32_dpp v217, v215 row_newbcast:6 row_mask:0xf bank_mask:0xf
    v_perm_b32 v96, v217, v217, v52
    v_perm_b32 v97, v217, v217, v53
    v_perm_b32 v98, v217, v217, v54
    v_perm_b32 v99, v217, v217, v55
    s_nop 1
    v_mfma_f32_16x16x32_bf16 v[160:163], a[72:75], v[96:99], v[160:163]
    v_mov_b32_dpp v216, v209 row_newbcast:7 row_mask:0xf bank_mask:0xf
    v_perm_b32 v92, v216, v216, v52
    v_perm_b32 v93, v216, v216, v53
    v_perm_b32 v94, v216, v216, v54
    v_perm_b32 v95, v216, v216, v55
    s_addk_i32 s44, 0x4000
    s_cmp_gt_i32 s53, 10
    s_cbranch_scc1 L_cw245
    s_waitcnt vmcnt(4)
L_cw245:
    s_waitcnt vmcnt(8)
    s_barrier
    buffer_load_dwordx4 a[244:247], v9, s[24:27], s44 offen nt
    v_mfma_f32_16x16x32_bf16 v[160:163], a[88:91], v[92:95], v[160:163]
    v_mov_b32_dpp v217, v211 row_newbcast:7 row_mask:0xf bank_mask:0xf
    v_perm_b32 v96, v217, v217, v52
    v_perm_b32 v97, v217, v217, v53
    v_perm_b32 v98, v217, v217, v54
    v_perm_b32 v99, v217, v217, v55
    s_nop 1
    v_mfma_f32_16x16x32_bf16 v[160:163], a[104:107], v[96:99], v[160:163]
    v_mov_b32_dpp v216, v213 row_newbcast:7 row_mask:0xf bank_mask:0xf
    v_perm_b32 v92, v216, v216, v52
    v_perm_b32 v93, v216, v216, v53
    v_perm_b32 v94, v216, v216, v54
    v_perm_b32 v95, v216, v216, v55
    s_addk_i32 s44, 0x4000
    s_cmp_gt_i32 s53, 11
    s_cbranch_scc1 L_cw246
    s_waitcnt vmcnt(4)
L_cw246:
    s_waitcnt vmcnt(6)
    s_barrier
    buffer_load_dwordx4 a[248:251], v9, s[24:27], s44 offen nt
    v_cmp_eq_u32 s[58:59], v101, v100
    s_bcnt1_i32_b32 s53, s58
    s_mul_i32 s53, s53, 256
    s_sub_i32 s53, s53, 4352
    s_lshl_b32 s58, s51, 8
    s_add_i32 s58, s58, s68
    s_mul_i32 s58, s58, 10
    s_ashr_i32 s58, s58, 5
    s_add_i32 s53, s53, s58
    s_ashr_i32 s53, s53, 8
    v_mfma_f32_16x16x32_bf16 v[160:163], a[120:123], v[92:95], v[160:163]
    v_mov_b32_dpp v217, v215 row_newbcast:7 row_mask:0xf bank_mask:0xf
    v_perm_b32 v96, v217, v217, v52
    v_perm_b32 v97, v217, v217, v53
    v_perm_b32 v98, v217, v217, v54
    v_perm_b32 v99, v217, v217, v55
    s_nop 1
    v_mfma_f32_16x16x32_bf16 v[160:163], a[76:79], v[96:99], v[160:163]
    v_mov_b32_dpp v216, v209 row_newbcast:8 row_mask:0xf bank_mask:0xf
    v_perm_b32 v92, v216, v216, v52
    v_perm_b32 v93, v216, v216, v53
    v_perm_b32 v94, v216, v216, v54
    v_perm_b32 v95, v216, v216, v55
    s_addk_i32 s44, 0x4000
    s_cmp_gt_i32 s53, 0
    s_cbranch_scc1 L_cw247
    s_waitcnt vmcnt(4)
L_cw247:
    s_waitcnt vmcnt(6)
    s_barrier
    buffer_load_dwordx4 a[252:255], v9, s[24:27], s44 offen nt
    v_mfma_f32_16x16x32_bf16 v[160:163], a[92:95], v[92:95], v[160:163]
    v_mov_b32_dpp v217, v211 row_newbcast:8 row_mask:0xf bank_mask:0xf
    v_perm_b32 v96, v217, v217, v52
    v_perm_b32 v97, v217, v217, v53
    v_perm_b32 v98, v217, v217, v54
    v_perm_b32 v99, v217, v217, v55
    s_nop 1
    v_mfma_f32_16x16x32_bf16 v[160:163], a[108:111], v[96:99], v[160:163]
    v_mov_b32_dpp v216, v213 row_newbcast:8 row_mask:0xf bank_mask:0xf
    v_perm_b32 v92, v216, v216, v52
    v_perm_b32 v93, v216, v216, v53
    v_perm_b32 v94, v216, v216, v54
    v_perm_b32 v95, v216, v216, v55
    s_addk_i32 s44, 0x4000
    s_cmp_gt_i32 s53, 1
    s_cbranch_scc1 L_cw248
    s_waitcnt vmcnt(4)
L_cw248:
    s_waitcnt vmcnt(6)
    s_barrier
    buffer_load_dwordx4 a[128:131], v9, s[24:27], s44 offen nt
    buffer_load_dword v100, v6, s[32:35], 0 offen offset:1408
    buffer_store_dword v101, v7, s[32:35], s54 offen offset:1408
    v_mfma_f32_16x16x32_bf16 v[160:163], a[124:127], v[92:95], v[160:163]
    v_mov_b32_dpp v217, v215 row_newbcast:8 row_mask:0xf bank_mask:0xf
    v_perm_b32 v96, v217, v217, v52
    v_perm_b32 v97, v217, v217, v53
    v_perm_b32 v98, v217, v217, v54
    v_perm_b32 v99, v217, v217, v55
    s_addk_i32 s44, 0x4000
    s_cmp_gt_i32 s53, 2
    s_cbranch_scc1 L_cw249
    s_waitcnt vmcnt(6)
L_cw249:
    s_waitcnt vmcnt(8)
    s_barrier
    buffer_load_dwordx4 a[132:135], v9, s[24:27], s44 offen nt
    v_mfma_f32_16x16x32_bf16 v[160:163], a[204:207], v[96:99], v[160:163]
    v_mov_b32_dpp v216, v209 row_newbcast:9 row_mask:0xf bank_mask:0xf
    v_perm_b32 v92, v216, v216, v52
    v_perm_b32 v93, v216, v216, v53
    v_perm_b32 v94, v216, v216, v54
    v_perm_b32 v95, v216, v216, v55
    s_nop 1
    v_mfma_f32_16x16x32_bf16 v[160:163], a[208:211], v[92:95], v[160:163]
    v_mov_b32_dpp v217, v211 row_newbcast:9 row_mask:0xf bank_mask:0xf
    v_perm_b32 v96, v217, v217, v52
    v_perm_b32 v97, v217, v217, v53
    v_perm_b32 v98, v217, v217, v54
    v_perm_b32 v99, v217, v217, v55
    s_addk_i32 s44, 0x4000
    s_cmp_gt_i32 s53, 3
    s_cbranch_scc1 L_cw250
    s_waitcnt vmcnt(6)
L_cw250:
    s_waitcnt vmcnt(8)
    s_barrier
    buffer_load_dwordx4 a[136:139], v9, s[24:27], s44 offen nt
    v_mfma_f32_16x16x32_bf16 v[160:163], a[212:215], v[96:99], v[160:163]
    v_mov_b32_dpp v216, v213 row_newbcast:9 row_mask:0xf bank_mask:0xf
    v_perm_b32 v92, v216, v216, v52
    v_perm_b32 v93, v216, v216, v53
    v_perm_b32 v94, v216, v216, v54
    v_perm_b32 v95, v216, v216, v55
    s_nop 1
    v_mfma_f32_16x16x32_bf16 v[160:163], a[216:219], v[92:95], v[160:163]
    v_mov_b32_dpp v217, v215 row_newbcast:9 row_mask:0xf bank_mask:0xf
    v_perm_b32 v96, v217, v217, v52
    v_perm_b32 v97, v217, v217, v53
    v_perm_b32 v98, v217, v217, v54
    v_perm_b32 v99, v217, v217, v55
    s_addk_i32 s44, 0x4000
    s_cmp_gt_i32 s53, 4
    s_cbranch_scc1 L_cw251
    s_waitcnt vmcnt(6)
L_cw251:
    s_waitcnt vmcnt(8)
    s_barrier
    buffer_load_dwordx4 a[140:143], v9, s[24:27], s44 offen nt
    v_mfma_f32_16x16x32_bf16 v[160:163], a[220:223], v[96:99], v[160:163]
    v_mov_b32_dpp v216, v209 row_newbcast:10 row_mask:0xf bank_mask:0xf
    v_perm_b32 v92, v216, v216, v52
    v_perm_b32 v93, v216, v216, v53
    v_perm_b32 v94, v216, v216, v54
    v_perm_b32 v95, v216, v216, v55
    s_nop 1
    v_mfma_f32_16x16x32_bf16 v[160:163], a[224:227], v[92:95], v[160:163]
    v_mov_b32_dpp v217, v211 row_newbcast:10 row_mask:0xf bank_mask:0xf
    v_perm_b32 v96, v217, v217, v52
    v_perm_b32 v97, v217, v217, v53
    v_perm_b32 v98, v217, v217, v54
    v_perm_b32 v99, v217, v217, v55
    s_addk_i32 s44, 0x4000
    s_cmp_gt_i32 s53, 5
    s_cbranch_scc1 L_cw252
    s_waitcnt vmcnt(6)
L_cw252:
    s_waitcnt vmcnt(8)
    s_barrier
    buffer_load_dwordx4 a[144:147], v9, s[24:27], s44 offen nt
    v_mfma_f32_16x16x32_bf16 v[160:163], a[228:231], v[96:99], v[160:163]
    v_mov_b32_dpp v216, v213 row_newbcast:10 row_mask:0xf bank_mask:0xf
    v_perm_b32 v92, v216, v216, v52
    v_perm_b32 v93, v216, v216, v53
    v_perm_b32 v94, v216, v216, v54
    v_perm_b32 v95, v216, v216, v55
    s_nop 1
    v_mfma_f32_16x16x32_bf16 v[160:163], a[232:235], v[92:95], v[160:163]
    v_mov_b32_dpp v217, v215 row_newbcast:10 row_mask:0xf bank_mask:0xf
    v_perm_b32 v96, v217, v217, v52
    v_perm_b32 v97, v217, v217, v53
    v_perm_b32 v98, v217, v217, v54
    v_perm_b32 v99, v217, v217, v55
    s_addk_i32 s44, 0x4000
    s_cmp_gt_i32 s53, 6
    s_cbranch_scc1 L_cw253
    s_waitcnt vmcnt(6)
L_cw253:
    s_waitcnt vmcnt(8)
    s_barrier
    buffer_load_dwordx4 a[0:3], v9, s[24:27], s44 offen nt
    v_mfma_f32_16x16x32_bf16 v[160:163], a[236:239], v[96:99], v[160:163]
    v_mov_b32_dpp v216, v209 row_newbcast:11 row_mask:0xf bank_mask:0xf
    v_perm_b32 v92, v216, v216, v52
    v_perm_b32 v93, v216, v216, v53
    v_perm_b32 v94, v216, v216, v54
    v_perm_b32 v95, v216, v216, v55
    s_nop 1
    v_mfma_f32_16x16x32_bf16 v[160:163], a[240:243], v[92:95], v[160:163]
    v_mov_b32_dpp v217, v211 row_newbcast:11 row_mask:0xf bank_mask:0xf
    v_perm_b32 v96, v217, v217, v52
    v_perm_b32 v97, v217, v217, v53
    v_perm_b32 v98, v217, v217, v54
    v_perm_b32 v99, v217, v217, v55
    s_addk_i32 s44, 0x4000
    s_cmp_gt_i32 s53, 7
    s_cbranch_scc1 L_cw254
    s_waitcnt vmcnt(4)
L_cw254:
    s_waitcnt vmcnt(8)
    s_barrier
    buffer_load_dwordx4 a[4:7], v9, s[24:27], s44 offen nt
    v_mfma_f32_16x16x32_bf16 v[160:163], a[244:247], v[96:99], v[160:163]
    v_mov_b32_dpp v216, v213 row_newbcast:11 row_mask:0xf bank_mask:0xf
    v_perm_b32 v92, v216, v216, v52
    v_perm_b32 v93, v216, v216, v53
    v_perm_b32 v94, v216, v216, v54
    v_perm_b32 v95, v216, v216, v55
    s_nop 1
    v_mfma_f32_16x16x32_bf16 v[160:163], a[248:251], v[92:95], v[160:163]
    v_mov_b32_dpp v217, v215 row_newbcast:11 row_mask:0xf bank_mask:0xf
    v_perm_b32 v96, v217, v217, v52
    v_perm_b32 v97, v217, v217, v53
    v_perm_b32 v98, v217, v217, v54
    v_perm_b32 v99, v217, v217, v55
    s_addk_i32 s44, 0x4000
    s_cmp_gt_i32 s53, 8
    s_cbranch_scc1 L_cw255
    s_waitcnt vmcnt(4)
L_cw255:
    s_waitcnt vmcnt(8)
    s_barrier
    buffer_load_dwordx4 a[8:11], v9, s[24:27], s44 offen nt
    v_mfma_f32_16x16x32_bf16 v[160:163], a[252:255], v[96:99], v[160:163]
    v_mov_b32_dpp v216, v209 row_newbcast:12 row_mask:0xf bank_mask:0xf
    v_perm_b32 v92, v216, v216, v52
    v_perm_b32 v93, v216, v216, v53
    v_perm_b32 v94, v216, v216, v54
    v_perm_b32 v95, v216, v216, v55
    s_nop 1
    v_mfma_f32_16x16x32_bf16 v[160:163], a[128:131], v[92:95], v[160:163]
    v_mov_b32_dpp v217, v211 row_newbcast:12 row_mask:0xf bank_mask:0xf
    v_perm_b32 v96, v217, v217, v52
    v_perm_b32 v97, v217, v217, v53
    v_perm_b32 v98, v217, v217, v54
    v_perm_b32 v99, v217, v217, v55
    s_addk_i32 s44, 0x4000
    s_cmp_gt_i32 s53, 9
    s_cbranch_scc1 L_cw256
    s_waitcnt vmcnt(4)
L_cw256:
    s_waitcnt vmcnt(6)
    s_barrier
    buffer_load_dwordx4 a[12:15], v9, s[24:27], s44 offen nt
    v_cmp_eq_u32 s[58:59], v101, v100
    s_bcnt1_i32_b32 s53, s58
    s_mul_i32 s53, s53, 205
    s_sub_i32 s53, s53, 3485
    s_lshl_b32 s58, s51, 8
    s_add_i32 s58, s58, s68
    s_mul_i32 s58, s58, 8
    s_ashr_i32 s58, s58, 5
    s_add_i32 s53, s53, s58
    s_ashr_i32 s53, s53, 8
    v_mfma_f32_16x16x32_bf16 v[160:163], a[132:135], v[96:99], v[160:163]
    v_mov_b32_dpp v216, v213 row_newbcast:12 row_mask:0xf bank_mask:0xf
    v_perm_b32 v92, v216, v216, v52
    v_perm_b32 v93, v216, v216, v53
    v_perm_b32 v94, v216, v216, v54
    v_perm_b32 v95, v216, v216, v55
    s_addk_i32 s44, 0x4000
    s_cmp_gt_i32 s53, 0
    s_cbranch_scc1 L_cw257
    s_waitcnt vmcnt(4)
L_cw257:
    s_waitcnt vmcnt(6)
    s_barrier
    buffer_load_dwordx4 a[16:19], v9, s[24:27], s44 offen nt
    v_mfma_f32_16x16x32_bf16 v[160:163], a[136:139], v[92:95], v[160:163]
    v_mov_b32_dpp v217, v215 row_newbcast:12 row_mask:0xf bank_mask:0xf
    v_perm_b32 v96, v217, v217, v52
    v_perm_b32 v97, v217, v217, v53
    v_perm_b32 v98, v217, v217, v54
    v_perm_b32 v99, v217, v217, v55
    s_addk_i32 s44, 0x4000
    s_cmp_gt_i32 s53, 1
    s_cbranch_scc1 L_cw258
    s_waitcnt vmcnt(4)
L_cw258:
    s_waitcnt vmcnt(6)
    s_barrier
    buffer_load_dwordx4 a[20:23], v9, s[24:27], s44 offen nt
    v_mfma_f32_16x16x32_bf16 v[160:163], a[140:143], v[96:99], v[160:163]
    v_mov_b32_dpp v216, v209 row_newbcast:13 row_mask:0xf bank_mask:0xf
    v_perm_b32 v92, v216, v216, v52
    v_perm_b32 v93, v216, v216, v53
    v_perm_b32 v94, v216, v216, v54
    v_perm_b32 v95, v216, v216, v55
    s_addk_i32 s44, 0x4000
    s_cmp_gt_i32 s53, 2
    s_cbranch_scc1 L_cw259
    s_waitcnt vmcnt(4)
L_cw259:
    s_waitcnt vmcnt(6)
    s_barrier
    buffer_load_dwordx4 a[24:27], v9, s[24:27], s44 offen nt
    v_mfma_f32_16x16x32_bf16 v[160:163], a[144:147], v[92:95], v[160:163]
    v_mov_b32_dpp v217, v211 row_newbcast:13 row_mask:0xf bank_mask:0xf
    v_perm_b32 v96, v217, v217, v52
    v_perm_b32 v97, v217, v217, v53
    v_perm_b32 v98, v217, v217, v54
    v_perm_b32 v99, v217, v217, v55
    s_addk_i32 s44, 0x4000
    s_cmp_gt_i32 s53, 3
    s_cbranch_scc1 L_cw260
    s_waitcnt vmcnt(4)
L_cw260:
    s_waitcnt vmcnt(6)
    s_barrier
    buffer_load_dwordx4 a[28:31], v9, s[24:27], s44 offen nt
    v_mfma_f32_16x16x32_bf16 v[160:163], a[0:3], v[96:99], v[160:163]
    v_mov_b32_dpp v216, v213 row_newbcast:13 row_mask:0xf bank_mask:0xf
    v_perm_b32 v92, v216, v216, v52
    v_perm_b32 v93, v216, v216, v53
    v_perm_b32 v94, v216, v216, v54
    v_perm_b32 v95, v216, v216, v55
    s_addk_i32 s44, 0x4000
    s_cmp_gt_i32 s53, 4
    s_cbranch_scc1 L_cw261
    s_waitcnt vmcnt(4)
L_cw261:
    s_waitcnt vmcnt(6)
    s_barrier
    buffer_load_dwordx4 a[32:35], v9, s[24:27], s44 offen nt
    v_mfma_f32_16x16x32_bf16 v[160:163], a[4:7], v[92:95], v[160:163]
    v_mov_b32_dpp v217, v215 row_newbcast:13 row_mask:0xf bank_mask:0xf
    v_perm_b32 v96, v217, v217, v52
    v_perm_b32 v97, v217, v217, v53
    v_perm_b32 v98, v217, v217, v54
    v_perm_b32 v99, v217, v217, v55
    s_addk_i32 s44, 0x4000
    s_cmp_gt_i32 s53, 5
    s_cbranch_scc1 L_cw262
    s_waitcnt vmcnt(4)
L_cw262:
    s_waitcnt vmcnt(6)
    s_barrier
    buffer_load_dwordx4 a[36:39], v9, s[24:27], s44 offen nt
    v_mfma_f32_16x16x32_bf16 v[160:163], a[8:11], v[96:99], v[160:163]
    v_mov_b32_dpp v216, v209 row_newbcast:14 row_mask:0xf bank_mask:0xf
    v_perm_b32 v92, v216, v216, v52
    v_perm_b32 v93, v216, v216, v53
    v_perm_b32 v94, v216, v216, v54
    v_perm_b32 v95, v216, v216, v55
    s_addk_i32 s44, 0x4000
    s_cmp_gt_i32 s53, 6
    s_cbranch_scc1 L_cw263
    s_waitcnt vmcnt(4)
L_cw263:
    s_waitcnt vmcnt(6)
    s_barrier
    buffer_load_dwordx4 a[40:43], v9, s[24:27], s44 offen nt
    v_mfma_f32_16x16x32_bf16 v[160:163], a[12:15], v[92:95], v[160:163]
    v_mov_b32_dpp v217, v211 row_newbcast:14 row_mask:0xf bank_mask:0xf
    v_perm_b32 v96, v217, v217, v52
    v_perm_b32 v97, v217, v217, v53
    v_perm_b32 v98, v217, v217, v54
    v_perm_b32 v99, v217, v217, v55
    s_waitcnt vmcnt(6)
    s_nop 0
    v_mfma_f32_16x16x32_bf16 v[160:163], a[16:19], v[96:99], v[160:163]
    v_mov_b32_dpp v216, v213 row_newbcast:14 row_mask:0xf bank_mask:0xf
    v_perm_b32 v92, v216, v216, v52
    v_perm_b32 v93, v216, v216, v53
    v_perm_b32 v94, v216, v216, v54
    v_perm_b32 v95, v216, v216, v55
    s_waitcnt vmcnt(5)
    buffer_load_dwordx4 v[60:63], v155, s[28:31], s45 offen offset:0 nt
    v_mfma_f32_16x16x32_bf16 v[160:163], a[20:23], v[92:95], v[160:163]
    v_mov_b32_dpp v217, v215 row_newbcast:14 row_mask:0xf bank_mask:0xf
    v_perm_b32 v96, v217, v217, v52
    v_perm_b32 v97, v217, v217, v53
    v_perm_b32 v98, v217, v217, v54
    v_perm_b32 v99, v217, v217, v55
    s_waitcnt vmcnt(5)
    buffer_load_dwordx4 v[64:67], v155, s[28:31], s45 offen offset:896 nt
    v_mfma_f32_16x16x32_bf16 v[160:163], a[24:27], v[96:99], v[160:163]
    v_mov_b32_dpp v216, v209 row_newbcast:15 row_mask:0xf bank_mask:0xf
    v_perm_b32 v92, v216, v216, v52
    v_perm_b32 v93, v216, v216, v53
    v_perm_b32 v94, v216, v216, v54
    v_perm_b32 v95, v216, v216, v55
    s_waitcnt vmcnt(5)
    buffer_store_dword v229, v228, s[32:35], s60 offen sc1
    buffer_load_dwordx4 v[68:71], v155, s[28:31], s45 offen offset:1792 nt
    v_mfma_f32_16x16x32_bf16 v[160:163], a[28:31], v[92:95], v[160:163]
    v_mov_b32_dpp v217, v211 row_newbcast:15 row_mask:0xf bank_mask:0xf
    v_perm_b32 v96, v217, v217, v52
    v_perm_b32 v97, v217, v217, v53
    v_perm_b32 v98, v217, v217, v54
    v_perm_b32 v99, v217, v217, v55
    s_waitcnt vmcnt(6)
    buffer_load_dwordx4 v[72:75], v155, s[28:31], s45 offen offset:2688 nt
    v_mfma_f32_16x16x32_bf16 v[160:163], a[32:35], v[96:99], v[160:163]
    v_mov_b32_dpp v216, v213 row_newbcast:15 row_mask:0xf bank_mask:0xf
    v_perm_b32 v92, v216, v216, v52
    v_perm_b32 v93, v216, v216, v53
    v_perm_b32 v94, v216, v216, v54
    v_perm_b32 v95, v216, v216, v55
    s_waitcnt vmcnt(6)
    s_addk_i32 s45, 3584
    buffer_load_dwordx4 v[76:79], v155, s[28:31], s45 offen offset:0 nt
    v_mfma_f32_16x16x32_bf16 v[160:163], a[36:39], v[92:95], v[160:163]
    v_mov_b32_dpp v217, v215 row_newbcast:15 row_mask:0xf bank_mask:0xf
    v_perm_b32 v96, v217, v217, v52
    v_perm_b32 v97, v217, v217, v53
    v_perm_b32 v98, v217, v217, v54
    v_perm_b32 v99, v217, v217, v55
    s_waitcnt vmcnt(6)
    s_nop 0
    v_mfma_f32_16x16x32_bf16 v[160:163], a[40:43], v[96:99], v[160:163]
    buffer_load_dwordx4 v[80:83], v155, s[28:31], s45 offen offset:896 nt
    buffer_load_dword v15, v152, s[32:35], s62 offen sc1
    buffer_load_dwordx4 v[84:87], v155, s[28:31], s45 offen offset:1792 nt
    buffer_load_dwordx4 v[88:91], v155, s[28:31], s45 offen offset:2688 nt
    s_mov_b32 exec_lo, 0x00ff00ff
    s_mov_b32 exec_hi, 0xff00ff00
    s_nop 1
    ds_write_b128 v218, v[160:163] offset:4352
    s_mov_b64 exec, -1
    s_waitcnt lgkmcnt(0)
    s_barrier
    s_cmp_lg_u32 s42, 0
    s_cbranch_scc1 L_near_o
    ds_read2st64_b32 v[20:21], v219 offset0:17 offset1:18
    ds_read2st64_b32 v[22:23], v219 offset0:19 offset1:20
    ds_read2st64_b32 v[24:25], v219 offset0:21 offset1:22
    ds_read2st64_b32 v[26:27], v219 offset0:23 offset1:24
    s_waitcnt lgkmcnt(3)
    v_add_f32 v20, v20, v21
    v_mul_f32 v20, v20, v148
    s_waitcnt lgkmcnt(2)
    v_add_f32 v22, v22, v23
    v_fmac_f32 v20, v22, v149
    s_waitcnt lgkmcnt(1)
    v_add_f32 v24, v24, v25
    v_fmac_f32 v20, v24, v150
    s_waitcnt lgkmcnt(0)
    v_add_f32 v26, v26, v27
    v_fmac_f32 v20, v26, v151
    v_cvt_pk_bf16_f32 v20, v20, v20
    v_bfi_b32 v20, v146, v154, v20
    buffer_store_dword v20, v59, s[32:35], s60 offen sc1
L_near_o:
    s_and_b32 s3, s50, 15
    s_cmp_ge_u32 s3, 14
    s_cbranch_scc1 L_done
    s_waitcnt vmcnt(8)
    v_perm_b32 v172, v64, v60, s46
    v_perm_b32 v176, v64, v60, s47
    v_perm_b32 v180, v65, v61, s46
    v_perm_b32 v184, v65, v61, s47
    v_perm_b32 v188, v66, v62, s46
    v_perm_b32 v192, v66, v62, s47
    v_perm_b32 v196, v67, v63, s46
    v_perm_b32 v200, v67, v63, s47
    s_waitcnt vmcnt(5)
    v_perm_b32 v173, v72, v68, s46
    v_perm_b32 v177, v72, v68, s47
    v_perm_b32 v181, v73, v69, s46
    v_perm_b32 v185, v73, v69, s47
    v_perm_b32 v189, v74, v70, s46
    v_perm_b32 v193, v74, v70, s47
    v_perm_b32 v197, v75, v71, s46
    v_perm_b32 v201, v75, v71, s47
    s_waitcnt vmcnt(3)
    buffer_load_dwordx4 v[104:107], v153, s[32:35], s61 offen offset:0 sc1
    buffer_load_dwordx4 v[108:111], v153, s[32:35], s61 offen offset:16 sc1
    v_perm_b32 v174, v80, v76, s46
    v_perm_b32 v178, v80, v76, s47
    v_perm_b32 v182, v81, v77, s46
    v_perm_b32 v186, v81, v77, s47
    v_perm_b32 v190, v82, v78, s46
    v_perm_b32 v194, v82, v78, s47
    v_perm_b32 v198, v83, v79, s46
    v_perm_b32 v202, v83, v79, s47
    s_waitcnt vmcnt(2)
    v_perm_b32 v175, v88, v84, s46
    v_perm_b32 v179, v88, v84, s47
    v_perm_b32 v183, v89, v85, s46
    v_perm_b32 v187, v89, v85, s47
    v_perm_b32 v191, v90, v86, s46
    v_perm_b32 v195, v90, v86, s47
    v_perm_b32 v199, v91, v87, s46
    v_perm_b32 v203, v91, v87, s47
L_chkO:
    s_waitcnt vmcnt(0)
    v_bitop3_b32 v2, v104, v108, s43 bitop3:0x7e
    v_bitop3_b32 v3, v105, v109, s65 bitop3:0x7e
    v_bitop3_b32 v4, v106, v110, s66 bitop3:0x7e
    v_or3_b32 v2, v2, v3, v4
    v_bitop3_b32 v3, v107, v111, s67 bitop3:0x7e
    v_or_b32 v2, v2, v3
    v_and_b32 v2, 0xff, v2
    v_cmp_ne_u32 vcc, 0, v2
    v_perm_b32 v16, v105, v104, s47
    v_perm_b32 v17, v107, v106, s47
    v_perm_b32 v18, v109, v108, s47
    v_perm_b32 v19, v111, v110, s47
    s_cbranch_vccnz L_pollO
L_gotO:
    s_bitcmp1_b32 s2, 5
    s_cbranch_scc1 L_addB
L_proj:
    v_mfma_f32_16x16x32_bf16 v[60:63], v[16:19], v[172:175], 0
    v_mfma_f32_16x16x32_bf16 v[64:67], v[16:19], v[176:179], 0
    v_mfma_f32_16x16x32_bf16 v[68:71], v[16:19], v[180:183], 0
    v_mfma_f32_16x16x32_bf16 v[72:75], v[16:19], v[184:187], 0
    v_mfma_f32_16x16x32_bf16 v[76:79], v[16:19], v[188:191], 0
    v_mfma_f32_16x16x32_bf16 v[80:83], v[16:19], v[192:195], 0
    v_mfma_f32_16x16x32_bf16 v[84:87], v[16:19], v[196:199], 0
    v_mfma_f32_16x16x32_bf16 v[88:91], v[16:19], v[200:203], 0
    s_nop 0
    v_add_f32_dpp v20, v61, v60 row_ror:8 row_mask:0xf bank_mask:0x3
    v_add_f32_dpp v20, v64, v65 row_ror:8 row_mask:0xf bank_mask:0xc
    v_add_f32_dpp v21, v69, v68 row_ror:8 row_mask:0xf bank_mask:0x3
    v_add_f32_dpp v21, v72, v73 row_ror:8 row_mask:0xf bank_mask:0xc
    v_add_f32_dpp v22, v77, v76 row_ror:8 row_mask:0xf bank_mask:0x3
    v_add_f32_dpp v22, v80, v81 row_ror:8 row_mask:0xf bank_mask:0xc
    v_add_f32_dpp v23, v85, v84 row_ror:8 row_mask:0xf bank_mask:0x3
    v_add_f32_dpp v23, v88, v89 row_ror:8 row_mask:0xf bank_mask:0xc
    ds_write_b128 v57, v[20:23] offset:0
    s_waitcnt lgkmcnt(0)
    s_barrier
    ds_read2st64_b32 v[20:21], v58 offset0:0 offset1:4
    ds_read2st64_b32 v[22:23], v58 offset0:8 offset1:12
    s_cmp_lg_u32 s52, 0
    s_waitcnt lgkmcnt(0)
    v_add_f32 v20, v20, v21
    v_add_f32 v22, v22, v23
    v_add_f32 v20, v20, v22
    v_bfi_b32 v21, v146, v154, v20
    s_mov_b64 exec, s[4:5]
    s_cbranch_scc1 L_far_y
    buffer_store_dword v21, v152, s[32:35], s62 offen
L_near_y:
    s_cmp_eq_u64 s[4:5], -1
    s_cbranch_scc1 L_done
    s_mov_b64 exec, -1
    buffer_load_dwordx4 v[172:175], v230, s[32:35], s63 offen sc1
    buffer_load_dwordx4 v[176:179], v231, s[32:35], s63 offen sc1
    ds_bpermute_b32 v22, v232, v20
    s_mov_b64 s[58:59], -1
    s_not_b32 s3, s43
    v_mov_b32 v180, s3
L_pollY:
    s_waitcnt vmcnt(2)
    v_bitop3_b32 v2, v180, v184, s43 bitop3:0x7e
    v_bitop3_b32 v3, v181, v185, s65 bitop3:0x7e
    v_bitop3_b32 v4, v182, v186, s66 bitop3:0x7e
    v_or3_b32 v2, v2, v3, v4
    v_bitop3_b32 v3, v183, v187, s67 bitop3:0x7e
    v_or_b32 v2, v2, v3
    v_and_b32 v2, 0xff, v2
    v_cmp_ne_u32 vcc, 0, v2
    s_wqm_b64 vcc, vcc
    s_andn2_b64 exec, s[58:59], vcc
    v_and_b32 v208, 0xffffff00, v180
    v_and_b32 v209, 0xffffff00, v181
    v_and_b32 v210, 0xffffff00, v182
    v_and_b32 v211, 0xffffff00, v183
    v_and_b32 v212, 0xffffff00, v184
    v_and_b32 v213, 0xffffff00, v185
    v_and_b32 v214, 0xffffff00, v186
    v_and_b32 v215, 0xffffff00, v187
    s_and_b64 s[58:59], s[58:59], vcc
    s_cbranch_scc0 L_gotY
    s_mov_b64 exec, s[58:59]
    buffer_load_dwordx4 v[180:183], v230, s[32:35], s63 offen sc1
    buffer_load_dwordx4 v[184:187], v231, s[32:35], s63 offen sc1
    s_mov_b64 exec, -1
    s_waitcnt vmcnt(2)
    v_bitop3_b32 v2, v172, v176, s43 bitop3:0x7e
    v_bitop3_b32 v3, v173, v177, s65 bitop3:0x7e
    v_bitop3_b32 v4, v174, v178, s66 bitop3:0x7e
    v_or3_b32 v2, v2, v3, v4
    v_bitop3_b32 v3, v175, v179, s67 bitop3:0x7e
    v_or_b32 v2, v2, v3
    v_and_b32 v2, 0xff, v2
    v_cmp_ne_u32 vcc, 0, v2
    s_wqm_b64 vcc, vcc
    s_andn2_b64 exec, s[58:59], vcc
    v_and_b32 v208, 0xffffff00, v172
    v_and_b32 v209, 0xffffff00, v173
    v_and_b32 v210, 0xffffff00, v174
    v_and_b32 v211, 0xffffff00, v175
    v_and_b32 v212, 0xffffff00, v176
    v_and_b32 v213, 0xffffff00, v177
    v_and_b32 v214, 0xffffff00, v178
    v_and_b32 v215, 0xffffff00, v179
    s_and_b64 s[58:59], s[58:59], vcc
    s_cbranch_scc0 L_gotY
    s_mov_b64 exec, s[58:59]
    buffer_load_dwordx4 v[172:175], v230, s[32:35], s63 offen sc1
    buffer_load_dwordx4 v[176:179], v231, s[32:35], s63 offen sc1
    s_mov_b64 exec, -1
    s_add_u32 s49, s49, 1
    s_cmp_gt_u32 s49, 0x20000
    s_cbranch_scc0 L_pollY
L_gotY:
    s_mov_b64 exec, -1
    s_not_b64 exec, s[6:7]
    v_add_f32 v208, v208, v212
    v_add_f32 v209, v209, v213
    v_add_f32 v210, v210, v214
    v_add_f32 v211, v211, v215
    s_mov_b64 exec, -1
    v_permlane32_swap_b32 v208, v209
    v_permlane32_swap_b32 v210, v211
    v_add_f32 v208, v208, v209
    v_add_f32 v210, v210, v211
    s_nop 1
    v_permlane16_swap_b32 v208, v210
    v_add_f32 v208, v208, v210
    s_nop 1
    v_add_f32_dpp v208, v208, v208 row_ror:8 row_mask:0xf bank_mask:0xf
    s_waitcnt lgkmcnt(0)
    v_add_f32 v208, v208, v22
    v_cvt_pk_bf16_f32 v208, v208, v208
    s_mov_b32 exec_lo, 0x00ff00ff
    s_mov_b32 exec_hi, 0x00ff00ff
    buffer_store_short v208, v56, s[36:39], s64 offen
    s_cmp_lg_u32 s64, 0
    s_cbranch_scc1 L_done
    s_mov_b64 exec, 1
    v_mov_b32 v210, s43
    buffer_store_dword v210, v56, s[32:35], 0 offen
L_done:
L_end:
    s_endpgm
L_pollO:
    s_add_u32 s49, s49, 1
    s_cmp_gt_u32 s49, 0x40000
    s_cbranch_scc1 L_gotO
    s_wqm_b64 exec, vcc
    buffer_load_dwordx4 v[104:107], v153, s[32:35], s61 offen offset:0 sc1
    buffer_load_dwordx4 v[108:111], v153, s[32:35], s61 offen offset:16 sc1
    s_mov_b64 exec, -1
    s_branch L_chkO
L_addB:
    v_and_b32 v104, 0xffffff00, v104
    v_and_b32 v105, 0xffffff00, v105
    v_and_b32 v106, 0xffffff00, v106
    v_and_b32 v107, 0xffffff00, v107
    v_and_b32 v108, 0xffffff00, v108
    v_and_b32 v109, 0xffffff00, v109
    v_and_b32 v110, 0xffffff00, v110
    v_and_b32 v111, 0xffffff00, v111
    v_add_f32_dpp v104, v104, v104 quad_perm:[2,3,0,1] row_mask:0xf bank_mask:0xf
    v_add_f32_dpp v105, v105, v105 quad_perm:[2,3,0,1] row_mask:0xf bank_mask:0xf
    v_add_f32_dpp v106, v106, v106 quad_perm:[2,3,0,1] row_mask:0xf bank_mask:0xf
    v_add_f32_dpp v107, v107, v107 quad_perm:[2,3,0,1] row_mask:0xf bank_mask:0xf
    v_add_f32_dpp v108, v108, v108 quad_perm:[2,3,0,1] row_mask:0xf bank_mask:0xf
    v_add_f32_dpp v109, v109, v109 quad_perm:[2,3,0,1] row_mask:0xf bank_mask:0xf
    v_add_f32_dpp v110, v110, v110 quad_perm:[2,3,0,1] row_mask:0xf bank_mask:0xf
    v_add_f32_dpp v111, v111, v111 quad_perm:[2,3,0,1] row_mask:0xf bank_mask:0xf
    v_cvt_pk_bf16_f32 v16, v104, v105
    v_cvt_pk_bf16_f32 v17, v106, v107
    v_cvt_pk_bf16_f32 v18, v108, v109
    v_cvt_pk_bf16_f32 v19, v110, v111
    s_nop 0
    s_branch L_proj
L_far_q:
    buffer_store_dwordx2 v[28:29], v59, s[32:35], s3 offen sc1
    s_branch L_near_q
L_far_q0:
    buffer_load_dwordx4 v[60:63], v152, s[32:35], s60 offen offset:0 sc1
    s_branch L_near_q0
L_far_q1:
    buffer_load_dwordx4 v[64:67], v152, s[32:35], s60 offen offset:16 sc1
    s_branch L_near_q1
L_far_q2:
    buffer_load_dwordx4 v[68:71], v152, s[32:35], s60 offen offset:512 sc1
    s_branch L_near_q2
L_far_q3:
    buffer_load_dwordx4 v[72:75], v152, s[32:35], s60 offen offset:528 sc1
    s_branch L_near_q3
L_far_q4:
    buffer_load_dwordx4 v[76:79], v153, s[32:35], s61 offen offset:0 sc1
    s_branch L_near_q4
L_far_q5:
    buffer_load_dwordx4 v[80:83], v153, s[32:35], s61 offen offset:16 sc1
    s_branch L_near_q5
L_far_q6:
    buffer_load_dwordx4 v[84:87], v153, s[32:35], s61 offen offset:512 sc1
    s_branch L_near_q6
L_far_q7:
    buffer_load_dwordx4 v[88:91], v153, s[32:35], s61 offen offset:528 sc1
    s_branch L_near_q7
L_slow_q:
    s_add_u32 s49, s49, 1
    s_cmp_gt_u32 s49, 0x40000
    s_cbranch_scc1 L_back_q
    buffer_load_dwordx4 v[60:63], v152, s[32:35], s60 offen offset:0 sc1
    buffer_load_dwordx4 v[64:67], v152, s[32:35], s60 offen offset:16 sc1
    buffer_load_dwordx4 v[68:71], v152, s[32:35], s60 offen offset:512 sc1
    buffer_load_dwordx4 v[72:75], v152, s[32:35], s60 offen offset:528 sc1
    buffer_load_dwordx4 v[76:79], v153, s[32:35], s61 offen offset:0 sc1
    buffer_load_dwordx4 v[80:83], v153, s[32:35], s61 offen offset:16 sc1
    buffer_load_dwordx4 v[84:87], v153, s[32:35], s61 offen offset:512 sc1
    buffer_load_dwordx4 v[88:91], v153, s[32:35], s61 offen offset:528 sc1
    s_waitcnt vmcnt(0)
    v_bitop3_b32 v2, v61, v63, s43 bitop3:0x7e
    v_bitop3_b32 v3, v65, v67, s43 bitop3:0x7e
    v_bitop3_b32 v4, v69, v71, s43 bitop3:0x7e
    v_or3_b32 v2, v2, v3, v4
    v_bitop3_b32 v3, v73, v75, s43 bitop3:0x7e
    v_bitop3_b32 v4, v77, v79, s43 bitop3:0x7e
    v_or3_b32 v2, v2, v3, v4
    v_bitop3_b32 v3, v81, v83, s43 bitop3:0x7e
    v_bitop3_b32 v4, v85, v87, s43 bitop3:0x7e
    v_or3_b32 v2, v2, v3, v4
    v_bitop3_b32 v3, v89, v91, s43 bitop3:0x7e
    v_or_b32 v2, v2, v3
    v_cmp_ne_u32 vcc, 0, v2
    s_cbranch_vccnz L_slow_q
    s_branch L_back_q
L_far_sc:
    buffer_store_dwordx3 v[156:158], v56, s[32:35], s41 offen sc1
    s_branch L_near_sc
L_far_sc0:
    buffer_load_dwordx3 v[20:22], v56, s[32:35], s60 offen sc1
    s_branch L_near_sc0
L_far_sc1:
    buffer_load_dwordx3 v[24:26], v56, s[32:35], s61 offen sc1
    s_branch L_near_sc1
L_far_sc2:
    buffer_load_dwordx3 v[28:30], v56, s[32:35], s62 offen sc1
    s_branch L_near_sc2
L_far_sc3:
    buffer_load_dwordx3 v[32:34], v56, s[32:35], s63 offen sc1
    s_branch L_near_sc3
L_far_sc4:
    buffer_load_dword v36, v56, s[32:35], s64 offen offset:8 sc1
    s_branch L_near_sc4
L_far_sc5:
    buffer_load_dword v37, v56, s[32:35], s65 offen offset:8 sc1
    s_branch L_near_sc5
L_far_sc6:
    buffer_load_dword v38, v56, s[32:35], s66 offen offset:8 sc1
    s_branch L_near_sc6
L_far_sc7:
    buffer_load_dword v39, v56, s[32:35], s67 offen offset:8 sc1
    s_branch L_near_sc7
L_slow_sc:
    s_add_u32 s49, s49, 1
    s_cmp_gt_u32 s49, 0x40000
    s_cbranch_scc1 L_back_sc
    buffer_load_dwordx3 v[20:22], v56, s[32:35], s60 offen sc1
    buffer_load_dwordx3 v[24:26], v56, s[32:35], s61 offen sc1
    buffer_load_dwordx3 v[28:30], v56, s[32:35], s62 offen sc1
    buffer_load_dwordx3 v[32:34], v56, s[32:35], s63 offen sc1
    buffer_load_dword v36, v56, s[32:35], s64 offen offset:8 sc1
    buffer_load_dword v37, v56, s[32:35], s65 offen offset:8 sc1
    buffer_load_dword v38, v56, s[32:35], s66 offen offset:8 sc1
    buffer_load_dword v39, v56, s[32:35], s67 offen offset:8 sc1
    s_waitcnt vmcnt(0)
    v_bitop3_b32 v2, v22, v26, v154 bitop3:0x7e
    v_bitop3_b32 v3, v30, v34, v154 bitop3:0x7e
    v_bitop3_b32 v4, v36, v37, v154 bitop3:0x7e
    v_or3_b32 v2, v2, v3, v4
    v_bitop3_b32 v3, v38, v39, v154 bitop3:0x7e
    v_or_b32 v2, v2, v3
    v_and_b32 v2, 0xffff, v2
    v_cmp_ne_u32 vcc, 0, v2
    s_cbranch_vccnz L_slow_sc
    s_branch L_back_sc
L_far_y:
    buffer_store_dword v21, v152, s[32:35], s62 offen sc1
    s_branch L_near_y
L_code_end:
.section .rodata,"a"
.p2align 6
.amdhsa_kernel concat_heads__mha_block_cached__sliding_block_cached__decode_kernel
  .amdhsa_next_free_vgpr 512
  .amdhsa_next_free_sgpr 102
  .amdhsa_accum_offset 256
  .amdhsa_group_segment_fixed_size 0
  .amdhsa_kernarg_size 104
  .amdhsa_user_sgpr_count 2
  .amdhsa_user_sgpr_kernarg_segment_ptr 1
  .amdhsa_system_sgpr_workgroup_id_x 1
.end_amdhsa_kernel
```
